```python
import torch

def _softmax(x, axis=-1):
    return torch.softmax(x, dim=axis)
def _gelu(x):
    return torch.nn.functional.gelu(x, approximate="tanh")
def _silu(x):
    return torch.nn.functional.silu(x)
def _sigmoid(x):
    return torch.sigmoid(x)
def _layernorm(x, axis=-1, eps=1e-5):
    m = x.mean(dim=axis, keepdim=True)
    v = x.var(dim=axis, keepdim=True, unbiased=False)
    return (x - m) / torch.sqrt(v + eps)
def _scatter_add(tgt, idx, src, axis=0):
    return tgt.clone().index_add_(axis, idx, src)
def _segment_sum(src, seg, n):
    out = torch.zeros((n,) + src.shape[1:], dtype=src.dtype)
    return out.index_add_(0, seg, src)
def _pad(x, pw):
    flat = tuple(v for pair in reversed(pw) for v in pair)
    return torch.nn.functional.pad(x, flat)

kernel_name = 'sequential_preLN__mha_block_cached__glu_gated_geglu__decode'

def setup_inputs():

    _w = (lambda a: (lambda t: t.to(torch.bfloat16) if t.is_floating_point() else t)(torch.as_tensor(a)))
    def _A_setup():
        B, Sq, D = 1, 1, 576
        H, Sk, Dh = 32, 16384, 128
        return {
            "x": _w((lambda *s: torch.randn(*s, dtype=torch.bfloat16) * 0.05)(B, Sq, D)),
            "k_cache": _w((lambda *s: torch.randn(*s, dtype=torch.bfloat16) * 3.2)(B, H, Sk, Dh)),
            "v_cache": _w((lambda *s: torch.randn(*s, dtype=torch.bfloat16) * 1.6)(B, H, Sk, Dh)),
            "wq": _w((lambda *s: torch.randn(*s, dtype=torch.bfloat16) * 3.2)(D, H * Dh) * (D ** -0.5)),
            "wo": _w((lambda *s: torch.randn(*s, dtype=torch.bfloat16) * 1.6)(H * Dh, D) * ((H * Dh) ** -0.5)),
        }
    _A_in = _A_setup()

    def _B_setup():
        B, S, Dm, Df = 1, 1, 576, 4608
        return {
            "x": _w((lambda *s: torch.randn(*s, dtype=torch.bfloat16) * 0.05)(B, S, Dm)),
            "w_gate": _w((lambda *s: torch.randn(*s, dtype=torch.bfloat16) * 1.6)(Dm, Df) * (Dm ** -0.5)),
            "w_up": _w((lambda *s: torch.randn(*s, dtype=torch.bfloat16) * 1.6)(Dm, Df) * (Dm ** -0.5)),
            "w_down": _w((lambda *s: torch.randn(*s, dtype=torch.bfloat16) * 1.6)(Df, Dm) * (Df ** -0.5)),
        }
    _B_in = _B_setup()

    return {
        "A_x": _A_in["x"],
        "A_k_cache": _A_in["k_cache"],
        "A_v_cache": _A_in["v_cache"],
        "A_wq": _A_in["wq"],
        "A_wo": _A_in["wo"],
        "B_x": _B_in["x"],
        "B_w_gate": _B_in["w_gate"],
        "B_w_up": _B_in["w_up"],
        "B_w_down": _B_in["w_down"],
    }

def reference(A_x, A_k_cache, A_v_cache, A_wq, A_wo, B_x, B_w_gate, B_w_up, B_w_down):
    def _A_ref(x, k_cache, v_cache, wq, wo):
        B, Sq, D = x.shape
        H, Dh = 32, 128
        q = (lambda x, *d: x.permute(*d))((x @ wq).reshape(B, Sq, H, Dh), 0, 2, 1, 3)
        scores = torch.einsum("bhqd,bhkd->bhqk", q, k_cache) * (Dh ** -0.5)
        p = _softmax(scores, axis=-1)
        o = torch.einsum("bhqk,bhkd->bhqd", p, v_cache)
        return (lambda x, *d: x.permute(*d))(o, 0, 2, 1, 3).reshape(B, Sq, H * Dh) @ wo

    def _B_ref(x, w_gate, w_up, w_down):
        g = torch.einsum("bsd,df->bsf", x, w_gate)
        u = torch.einsum("bsd,df->bsf", x, w_up)
        h = _gelu(g) * u
        return torch.einsum("bsf,fd->bsd", h, w_down)

    x = A_x
    h = x + _A_ref(_layernorm(x, axis=-1), A_k_cache, A_v_cache, A_wq, A_wo)
    h2 = h + _B_ref(_layernorm(h, axis=-1), B_w_gate, B_w_up, B_w_down)
    return h2
```

```asm
; @launch grid=(256,1,1) block=(512,1,1) lds=94208
.amdgcn_target "amdgcn-amd-amdhsa--gfx950"
.text
.globl sequential_preLN__mha_block_cached__glu_gated_geglu__decode_kernel
.p2align 8
.type sequential_preLN__mha_block_cached__glu_gated_geglu__decode_kernel,@function
sequential_preLN__mha_block_cached__glu_gated_geglu__decode_kernel:
    s_cmp_ge_u32 s2, 256
    s_cbranch_scc1 L_END
    s_load_dwordx16 s[16:31], s[0:1], 0
    s_load_dwordx8 s[32:39], s[0:1], 64
    v_add_u32 v0, 448, v0
    v_and_b32 v1, 63, v0
    v_and_b32 v0, 511, v0
    v_lshrrev_b32 v24, 6, v0
    v_lshlrev_b32 v4, 4, v1
    v_readfirstlane_b32 s3, v24
    v_mov_b32 v24, 29
    v_mov_b32 v25, 0
    v_mov_b32 v26, 0
    v_mov_b32 v27, 0
    ds_write_b128 v25, v[24:27] offset:6080
    v_lshrrev_b32 v2, 4, v1
    v_and_b32 v3, 15, v1
    s_lshr_b32 s4, s2, 3
    s_and_b32 s15, s2, 7
    s_lshl_b32 s6, s4, 22
    s_add_u32 s10, s2, s4
    s_and_b32 s10, s10, 7
    s_cmp_lt_u32 s4, 8
    s_cselect_b32 s7, 3, 2
    s_cmp_lt_u32 s10, s7
    s_cselect_b32 s14, 28, 0
    s_sub_u32 s14, 104, s14
    s_min_u32 s8, s10, s7
    s_mul_i32 s8, s8, 28
    s_mul_i32 s5, s10, 104
    s_sub_u32 s5, s5, s8
    s_mul_i32 s7, s7, 28
    s_mov_b32 s42, 0x400000
    s_mov_b32 s43, 0x20000
    s_mov_b32 s46, 0x400000
    s_mov_b32 s47, 0x20000
    s_add_u32 s85, s3, s5
    v_lshlrev_b32 v248, 4, v3
    v_lshl_add_u32 v248, v2, 12, v248
    v_add_u32 v249, 16384, v248
    v_add_u32 v251, 32768, v248
    v_add_u32 v252, 49152, v248
    s_and_b32 s84, s85, 15
    s_lshl_b32 s9, s85, 12
    s_mul_i32 s84, s84, 3840
    s_sub_u32 s9, s9, s84
    s_and_b32 s8, s3, 0
    s_lshl_b32 s79, s4, 0
    s_add_u32 s79, s79, s8
    s_sub_u32 s7, s7, s8
    s_mul_i32 s79, s79, 256
    s_add_u32 s79, s79, 2097152
    s_waitcnt lgkmcnt(0)
    s_load_dword s76, s[38:39], 786432
    s_add_u32 s40, s18, s6
    s_addc_u32 s41, s19, 0
    s_add_u32 s44, s20, s6
    s_addc_u32 s45, s21, 0
    s_cmp_lt_u32 s3, 7
    s_cbranch_scc0 L_nofirst
    buffer_load_dwordx4 v[48:51], v248, s[40:43], s9 offen nt
    buffer_load_dwordx4 v[52:55], v249, s[40:43], s9 offen nt
    buffer_load_dwordx4 v[56:59], v251, s[40:43], s9 offen nt
    buffer_load_dwordx4 v[60:63], v252, s[40:43], s9 offen nt
    buffer_load_dwordx4 v[64:67], v248, s[44:47], s9 offen nt
    buffer_load_dwordx4 v[68:71], v249, s[44:47], s9 offen nt
    buffer_load_dwordx4 v[72:75], v251, s[44:47], s9 offen nt
    buffer_load_dwordx4 v[76:79], v252, s[44:47], s9 offen nt
    s_add_u32 s85, s85, 7
    s_and_b32 s84, s85, 15
    s_lshl_b32 s9, s85, 12
    s_mul_i32 s84, s84, 3840
    s_sub_u32 s9, s9, s84
    buffer_load_dwordx4 v[80:83], v248, s[40:43], s9 offen nt
    buffer_load_dwordx4 v[84:87], v249, s[40:43], s9 offen nt
    buffer_load_dwordx4 v[88:91], v251, s[40:43], s9 offen nt
    buffer_load_dwordx4 v[92:95], v252, s[40:43], s9 offen nt
    s_barrier
L_nofirst:
    s_mov_b32 s48, s16
    s_mov_b32 s49, s17
    s_mov_b32 s50, 1152
    s_mov_b32 s51, 0x20000
    s_mov_b32 s52, s22
    s_mov_b32 s53, s23
    s_mov_b32 s54, 4718592
    s_mov_b32 s55, 0x20000
    s_cmp_eq_u32 s3, 7
    s_cbranch_scc0 L_notq
    s_setprio 3
    s_load_dword s78, s[38:39], s79
    v_lshlrev_b32 v24, 1, v1
    buffer_load_ushort v194, v24, s[48:51], 0 offen offset:0
    buffer_load_ushort v195, v24, s[48:51], 0 offen offset:128
    buffer_load_ushort v196, v24, s[48:51], 0 offen offset:256
    buffer_load_ushort v197, v24, s[48:51], 0 offen offset:384
    buffer_load_ushort v198, v24, s[48:51], 0 offen offset:512
    buffer_load_ushort v199, v24, s[48:51], 0 offen offset:640
    buffer_load_ushort v200, v24, s[48:51], 0 offen offset:768
    buffer_load_ushort v201, v24, s[48:51], 0 offen offset:896
    buffer_load_ushort v202, v24, s[48:51], 0 offen offset:1024
    s_mul_i32 s10, s15, 144
    v_mul_u32_u24 v25, 36, v2
    buffer_load_dwordx4 v[184:187], v25, s[48:51], s10 offen
    buffer_load_dwordx4 v[188:191], v25, s[48:51], s10 offen offset:16
    buffer_load_dword v192, v25, s[48:51], s10 offen offset:32
    v_mul_u32_u24 v24, 147456, v2
    v_lshl_add_u32 v24, v3, 4, v24
    s_mul_i32 s10, s15, 589824
    s_lshl_b32 s15, s4, 8
    s_add_u32 s10, s10, s15
    buffer_load_dwordx4 v[112:115], v24, s[52:55], s10 offen nt
    s_add_u32 s10, s10, 8192
    buffer_load_dwordx4 v[116:119], v24, s[52:55], s10 offen nt
    s_add_u32 s10, s10, 8192
    buffer_load_dwordx4 v[120:123], v24, s[52:55], s10 offen nt
    s_add_u32 s10, s10, 8192
    buffer_load_dwordx4 v[124:127], v24, s[52:55], s10 offen nt
    s_add_u32 s10, s10, 8192
    buffer_load_dwordx4 v[128:131], v24, s[52:55], s10 offen nt
    s_add_u32 s10, s10, 8192
    buffer_load_dwordx4 v[132:135], v24, s[52:55], s10 offen nt
    s_add_u32 s10, s10, 8192
    buffer_load_dwordx4 v[136:139], v24, s[52:55], s10 offen nt
    s_add_u32 s10, s10, 8192
    buffer_load_dwordx4 v[140:143], v24, s[52:55], s10 offen nt
    s_add_u32 s10, s10, 8192
    buffer_load_dwordx4 v[144:147], v24, s[52:55], s10 offen nt
    s_add_u32 s10, s10, 8192
    buffer_load_dwordx4 v[148:151], v24, s[52:55], s10 offen nt
    s_add_u32 s10, s10, 8192
    buffer_load_dwordx4 v[152:155], v24, s[52:55], s10 offen nt
    s_add_u32 s10, s10, 8192
    buffer_load_dwordx4 v[156:159], v24, s[52:55], s10 offen nt
    s_add_u32 s10, s10, 8192
    buffer_load_dwordx4 v[160:163], v24, s[52:55], s10 offen nt
    s_add_u32 s10, s10, 8192
    buffer_load_dwordx4 v[164:167], v24, s[52:55], s10 offen nt
    s_add_u32 s10, s10, 8192
    buffer_load_dwordx4 v[168:171], v24, s[52:55], s10 offen nt
    s_add_u32 s10, s10, 8192
    buffer_load_dwordx4 v[172:175], v24, s[52:55], s10 offen nt
    s_add_u32 s10, s10, 8192
    buffer_load_dwordx4 v[176:179], v24, s[52:55], s10 offen nt
    s_add_u32 s10, s10, 8192
    buffer_load_dwordx4 v[180:183], v24, s[52:55], s10 offen nt
    s_barrier
L_notq:
    s_mov_b32 s68, s38
    s_mov_b32 s69, s39
    s_mov_b32 s70, 8388608
    s_mov_b32 s71, 0x20000
    s_mov_b32 s56, s24
    s_mov_b32 s57, s25
    s_mov_b32 s58, 4718592
    s_mov_b32 s59, 0x20000
    s_mov_b32 s60, s28
    s_mov_b32 s61, s29
    s_mov_b32 s62, 5308416
    s_mov_b32 s63, 0x20000
    s_mov_b32 s64, s30
    s_mov_b32 s65, s31
    s_mov_b32 s66, 5308416
    s_mov_b32 s67, 0x20000
    s_mov_b32 s80, s32
    s_mov_b32 s81, s33
    s_mov_b32 s82, 5308416
    s_mov_b32 s83, 0x20000
    s_mov_b32 s72, s34
    s_mov_b32 s73, s35
    s_mov_b32 s74, 1152
    s_mov_b32 s75, 0x20000
    s_add_u32 s10, s2, s4
    s_and_b32 s10, s10, 7
    s_mov_b32 s11, 0
    s_mov_b32 s33, 18
    s_mov_b32 s0, 5
    s_cmp_lt_u32 s4, 8
    s_cbranch_scc0 L_role_y
    s_mul_i32 s12, s4, 3
    s_add_u32 s12, s12, s10
    s_cmp_lt_u32 s10, 3
    s_cbranch_scc1 L_role_done
    s_mov_b32 s11, 2
    s_mov_b32 s33, 0
    s_mul_i32 s12, s4, 5
    s_add_u32 s12, s12, s10
    s_sub_u32 s12, s12, 3
    s_cmp_lt_u32 s12, 36
    s_cbranch_scc1 L_role_done
    s_mov_b32 s11, 3
    s_branch L_role_done
L_role_y:
    s_lshl_b32 s12, s4, 1
    s_add_u32 s12, s12, s10
    s_add_u32 s12, s12, 8
    s_cmp_lt_u32 s10, 2
    s_cbranch_scc1 L_role_done
    s_mov_b32 s11, 1
    s_mov_b32 s33, 16
    s_lshr_b32 s13, s4, 3
    s_mul_i32 s13, s13, 3
    s_add_u32 s13, s13, s10
    s_sub_u32 s13, s13, 5
    s_and_b32 s12, s2, 7
    s_cmp_lt_u32 s10, 5
    s_cbranch_scc1 L_role_done
    s_mov_b32 s11, 3
    s_mov_b32 s33, 0
L_role_done:
    s_mov_b32 s88, 0x3fb8aa3b
    s_mov_b32 s89, 0x3db504f3
    s_mov_b32 s91, 0
    s_mov_b32 s90, 0
    s_mov_b32 s39, 0
    s_mov_b32 s8, 0
    s_mov_b32 s36, 0
    s_cmp_eq_u32 s11, 0
    s_cselect_b32 s1, 0, 5
    s_mov_b32 s35, 0xffffff00
    s_lshl_b32 s15, s4, 1
    s_add_u32 s15, s15, s10
    s_cmp_lt_u32 s4, 8
    s_cselect_b32 s84, 1, 0
    s_sub_u32 s15, s15, s84
    s_cmp_eq_u32 s15, 33
    s_cselect_b32 s87, 67, 0
    s_cmp_eq_u32 s15, 63
    s_cselect_b32 s15, 33, s15
    s_add_u32 s86, s15, 4
    s_mul_i32 s86, s86, 37
    s_lshr_b32 s86, s86, 8
    s_add_u32 s15, s15, s86
    s_cmp_lg_u32 s87, 0
    s_cselect_b32 s15, s87, s15
    s_lshl_b32 s87, s4, 3
    s_add_u32 s87, s87, 3
    s_cmp_lt_u32 s10, s84
    s_cselect_b32 s15, s87, s15
    s_cmp_eq_u32 s11, 0
    s_cselect_b32 s12, s15, s12
    s_cmp_eq_u32 s3, 7
    s_cbranch_scc0 L_pace
L_qwave:
    v_and_b32 v24, 1, v1
    v_mov_b32 v25, 0xffff
    v_mov_b32 v26, 0xffff0000
    v_cmp_eq_u32 vcc, 1, v24
    s_nop 1
    v_cndmask_b32 v25, v25, v26, vcc
    v_bfe_u32 v24, v1, 1, 2
    v_cmp_eq_u32 vcc, 0, v24
    s_nop 1
    v_cndmask_b32 v40, 0, v25, vcc
    v_cmp_eq_u32 vcc, 1, v24
    s_nop 1
    v_cndmask_b32 v41, 0, v25, vcc
    v_cmp_eq_u32 vcc, 2, v24
    s_nop 1
    v_cndmask_b32 v42, 0, v25, vcc
    v_cmp_eq_u32 vcc, 3, v24
    s_nop 1
    v_cndmask_b32 v43, 0, v25, vcc
    s_waitcnt vmcnt(21)
    v_lshlrev_b32 v194, 16, v194
    v_lshlrev_b32 v195, 16, v195
    v_lshlrev_b32 v196, 16, v196
    v_lshlrev_b32 v197, 16, v197
    v_lshlrev_b32 v198, 16, v198
    v_lshlrev_b32 v199, 16, v199
    v_lshlrev_b32 v200, 16, v200
    v_lshlrev_b32 v201, 16, v201
    v_lshlrev_b32 v202, 16, v202
    v_add_f32 v24, v194, v195
    v_add_f32 v24, v24, v196
    v_add_f32 v24, v24, v197
    v_add_f32 v24, v24, v198
    v_add_f32 v24, v24, v199
    v_add_f32 v24, v24, v200
    v_add_f32 v24, v24, v201
    v_add_f32 v24, v24, v202
    s_nop 1
    v_add_f32_dpp v24, v24, v24 row_ror:8 row_mask:0xf bank_mask:0xf
    s_nop 1
    v_add_f32_dpp v24, v24, v24 row_ror:4 row_mask:0xf bank_mask:0xf
    s_nop 1
    v_add_f32_dpp v24, v24, v24 row_ror:2 row_mask:0xf bank_mask:0xf
    s_nop 1
    v_add_f32_dpp v24, v24, v24 row_ror:1 row_mask:0xf bank_mask:0xf
    v_mov_b32 v25, v24
    s_nop 1
    v_permlane16_swap_b32 v24, v25
    v_add_f32 v24, v24, v25
    v_mov_b32 v25, v24
    s_nop 1
    v_permlane32_swap_b32 v24, v25
    v_add_f32 v24, v24, v25
    v_mul_f32 v24, 0x3ae38e39, v24
    v_sub_f32 v26, v194, v24
    v_mul_f32 v27, v26, v26
    v_sub_f32 v26, v195, v24
    v_fmac_f32 v27, v26, v26
    v_sub_f32 v26, v196, v24
    v_fmac_f32 v27, v26, v26
    v_sub_f32 v26, v197, v24
    v_fmac_f32 v27, v26, v26
    v_sub_f32 v26, v198, v24
    v_fmac_f32 v27, v26, v26
    v_sub_f32 v26, v199, v24
    v_fmac_f32 v27, v26, v26
    v_sub_f32 v26, v200, v24
    v_fmac_f32 v27, v26, v26
    v_sub_f32 v26, v201, v24
    v_fmac_f32 v27, v26, v26
    v_sub_f32 v26, v202, v24
    v_fmac_f32 v27, v26, v26
    s_nop 1
    v_add_f32_dpp v27, v27, v27 row_ror:8 row_mask:0xf bank_mask:0xf
    s_nop 1
    v_add_f32_dpp v27, v27, v27 row_ror:4 row_mask:0xf bank_mask:0xf
    s_nop 1
    v_add_f32_dpp v27, v27, v27 row_ror:2 row_mask:0xf bank_mask:0xf
    s_nop 1
    v_add_f32_dpp v27, v27, v27 row_ror:1 row_mask:0xf bank_mask:0xf
    v_mov_b32 v25, v27
    s_nop 1
    v_permlane16_swap_b32 v27, v25
    v_add_f32 v27, v27, v25
    v_mov_b32 v25, v27
    s_nop 1
    v_permlane32_swap_b32 v27, v25
    v_add_f32 v27, v27, v25
    v_mul_f32 v27, 0x3ae38e39, v27
    v_cvt_pk_bf16_f32 v25, v24, v27
    v_lshlrev_b32 v28, 16, v25
    v_and_b32 v25, 0xffff0000, v25
    v_add_f32 v25, 0x3727c5ac, v25
    v_cvt_pk_bf16_f32 v25, v25, v25
    v_lshlrev_b32 v25, 16, v25
    v_sqrt_f32 v25, v25
    s_nop 0
    v_cvt_pk_bf16_f32 v25, v25, v25
    v_lshlrev_b32 v29, 16, v25
    v_rcp_f32 v30, v29
    s_waitcnt vmcnt(18)
    v_lshlrev_b32 v32, 16, v184
    v_and_b32 v33, 0xffff0000, v184
    v_sub_f32 v32, v32, v28
    v_sub_f32 v33, v33, v28
    v_cvt_pk_bf16_f32 v34, v32, v33
    v_lshlrev_b32 v32, 16, v34
    v_and_b32 v33, 0xffff0000, v34
    v_mul_f32 v34, v32, v30
    v_mul_f32 v35, v33, v30
    v_fma_f32 v32, -v34, v29, v32
    v_fma_f32 v33, -v35, v29, v33
    v_fmac_f32 v34, v32, v30
    v_fmac_f32 v35, v33, v30
    v_cvt_pk_bf16_f32 v204, v34, v34
    v_cvt_pk_bf16_f32 v205, v35, v35
    v_lshlrev_b32 v32, 16, v185
    v_and_b32 v33, 0xffff0000, v185
    v_sub_f32 v32, v32, v28
    v_sub_f32 v33, v33, v28
    v_cvt_pk_bf16_f32 v34, v32, v33
    v_lshlrev_b32 v32, 16, v34
    v_and_b32 v33, 0xffff0000, v34
    v_mul_f32 v34, v32, v30
    v_mul_f32 v35, v33, v30
    v_fma_f32 v32, -v34, v29, v32
    v_fma_f32 v33, -v35, v29, v33
    v_fmac_f32 v34, v32, v30
    v_fmac_f32 v35, v33, v30
    v_cvt_pk_bf16_f32 v206, v34, v34
    v_cvt_pk_bf16_f32 v207, v35, v35
    v_lshlrev_b32 v32, 16, v186
    v_and_b32 v33, 0xffff0000, v186
    v_sub_f32 v32, v32, v28
    v_sub_f32 v33, v33, v28
    v_cvt_pk_bf16_f32 v34, v32, v33
    v_lshlrev_b32 v32, 16, v34
    v_and_b32 v33, 0xffff0000, v34
    v_mul_f32 v34, v32, v30
    v_mul_f32 v35, v33, v30
    v_fma_f32 v32, -v34, v29, v32
    v_fma_f32 v33, -v35, v29, v33
    v_fmac_f32 v34, v32, v30
    v_fmac_f32 v35, v33, v30
    v_cvt_pk_bf16_f32 v208, v34, v34
    v_cvt_pk_bf16_f32 v209, v35, v35
    v_lshlrev_b32 v32, 16, v187
    v_and_b32 v33, 0xffff0000, v187
    v_sub_f32 v32, v32, v28
    v_sub_f32 v33, v33, v28
    v_cvt_pk_bf16_f32 v34, v32, v33
    v_lshlrev_b32 v32, 16, v34
    v_and_b32 v33, 0xffff0000, v34
    v_mul_f32 v34, v32, v30
    v_mul_f32 v35, v33, v30
    v_fma_f32 v32, -v34, v29, v32
    v_fma_f32 v33, -v35, v29, v33
    v_fmac_f32 v34, v32, v30
    v_fmac_f32 v35, v33, v30
    v_cvt_pk_bf16_f32 v210, v34, v34
    v_cvt_pk_bf16_f32 v211, v35, v35
    v_lshlrev_b32 v32, 16, v188
    v_and_b32 v33, 0xffff0000, v188
    v_sub_f32 v32, v32, v28
    v_sub_f32 v33, v33, v28
    v_cvt_pk_bf16_f32 v34, v32, v33
    v_lshlrev_b32 v32, 16, v34
    v_and_b32 v33, 0xffff0000, v34
    v_mul_f32 v34, v32, v30
    v_mul_f32 v35, v33, v30
    v_fma_f32 v32, -v34, v29, v32
    v_fma_f32 v33, -v35, v29, v33
    v_fmac_f32 v34, v32, v30
    v_fmac_f32 v35, v33, v30
    v_cvt_pk_bf16_f32 v212, v34, v34
    v_cvt_pk_bf16_f32 v213, v35, v35
    v_lshlrev_b32 v32, 16, v189
    v_and_b32 v33, 0xffff0000, v189
    v_sub_f32 v32, v32, v28
    v_sub_f32 v33, v33, v28
    v_cvt_pk_bf16_f32 v34, v32, v33
    v_lshlrev_b32 v32, 16, v34
    v_and_b32 v33, 0xffff0000, v34
    v_mul_f32 v34, v32, v30
    v_mul_f32 v35, v33, v30
    v_fma_f32 v32, -v34, v29, v32
    v_fma_f32 v33, -v35, v29, v33
    v_fmac_f32 v34, v32, v30
    v_fmac_f32 v35, v33, v30
    v_cvt_pk_bf16_f32 v214, v34, v34
    v_cvt_pk_bf16_f32 v215, v35, v35
    v_lshlrev_b32 v32, 16, v190
    v_and_b32 v33, 0xffff0000, v190
    v_sub_f32 v32, v32, v28
    v_sub_f32 v33, v33, v28
    v_cvt_pk_bf16_f32 v34, v32, v33
    v_lshlrev_b32 v32, 16, v34
    v_and_b32 v33, 0xffff0000, v34
    v_mul_f32 v34, v32, v30
    v_mul_f32 v35, v33, v30
    v_fma_f32 v32, -v34, v29, v32
    v_fma_f32 v33, -v35, v29, v33
    v_fmac_f32 v34, v32, v30
    v_fmac_f32 v35, v33, v30
    v_cvt_pk_bf16_f32 v216, v34, v34
    v_cvt_pk_bf16_f32 v217, v35, v35
    v_lshlrev_b32 v32, 16, v191
    v_and_b32 v33, 0xffff0000, v191
    v_sub_f32 v32, v32, v28
    v_sub_f32 v33, v33, v28
    v_cvt_pk_bf16_f32 v34, v32, v33
    v_lshlrev_b32 v32, 16, v34
    v_and_b32 v33, 0xffff0000, v34
    v_mul_f32 v34, v32, v30
    v_mul_f32 v35, v33, v30
    v_fma_f32 v32, -v34, v29, v32
    v_fma_f32 v33, -v35, v29, v33
    v_fmac_f32 v34, v32, v30
    v_fmac_f32 v35, v33, v30
    v_cvt_pk_bf16_f32 v218, v34, v34
    v_cvt_pk_bf16_f32 v219, v35, v35
    v_lshlrev_b32 v32, 16, v192
    v_and_b32 v33, 0xffff0000, v192
    v_sub_f32 v32, v32, v28
    v_sub_f32 v33, v33, v28
    v_cvt_pk_bf16_f32 v34, v32, v33
    v_lshlrev_b32 v32, 16, v34
    v_and_b32 v33, 0xffff0000, v34
    v_mul_f32 v34, v32, v30
    v_mul_f32 v35, v33, v30
    v_fma_f32 v32, -v34, v29, v32
    v_fma_f32 v33, -v35, v29, v33
    v_fmac_f32 v34, v32, v30
    v_fmac_f32 v35, v33, v30
    v_cvt_pk_bf16_f32 v220, v34, v34
    v_cvt_pk_bf16_f32 v221, v35, v35
    v_lshl_add_u32 v44, v2, 3, v3
    v_lshlrev_b32 v44, 4, v44
    v_mov_b32 v45, 1073741824
    v_cmp_gt_u32 vcc, 8, v3
    s_nop 1
    v_cndmask_b32 v44, v45, v44, vcc
    s_lshl_b32 s10, s2, 9
    s_add_u32 s10, s10, 655360
    s_waitcnt vmcnt(0)
    v_and_b32 v32, v204, v40
    v_and_b32 v33, v204, v41
    v_and_b32 v34, v204, v42
    v_and_b32 v35, v204, v43
    s_nop 1
    v_mfma_f32_16x16x32_bf16 v[24:27], v[112:115], v[32:35], 0
    v_and_b32 v36, v205, v40
    v_and_b32 v37, v205, v41
    v_and_b32 v38, v205, v42
    v_and_b32 v39, v205, v43
    s_nop 1
    v_mfma_f32_16x16x32_bf16 v[24:27], v[116:119], v[36:39], v[24:27]
    v_and_b32 v32, v206, v40
    v_and_b32 v33, v206, v41
    v_and_b32 v34, v206, v42
    v_and_b32 v35, v206, v43
    s_nop 1
    v_mfma_f32_16x16x32_bf16 v[24:27], v[120:123], v[32:35], v[24:27]
    v_and_b32 v36, v207, v40
    v_and_b32 v37, v207, v41
    v_and_b32 v38, v207, v42
    v_and_b32 v39, v207, v43
    s_nop 1
    v_mfma_f32_16x16x32_bf16 v[24:27], v[124:127], v[36:39], v[24:27]
    v_and_b32 v32, v208, v40
    v_and_b32 v33, v208, v41
    v_and_b32 v34, v208, v42
    v_and_b32 v35, v208, v43
    s_nop 1
    v_mfma_f32_16x16x32_bf16 v[24:27], v[128:131], v[32:35], v[24:27]
    v_and_b32 v36, v209, v40
    v_and_b32 v37, v209, v41
    v_and_b32 v38, v209, v42
    v_and_b32 v39, v209, v43
    s_nop 1
    v_mfma_f32_16x16x32_bf16 v[24:27], v[132:135], v[36:39], v[24:27]
    v_and_b32 v32, v210, v40
    v_and_b32 v33, v210, v41
    v_and_b32 v34, v210, v42
    v_and_b32 v35, v210, v43
    s_nop 1
    v_mfma_f32_16x16x32_bf16 v[24:27], v[136:139], v[32:35], v[24:27]
    v_and_b32 v36, v211, v40
    v_and_b32 v37, v211, v41
    v_and_b32 v38, v211, v42
    v_and_b32 v39, v211, v43
    s_nop 1
    v_mfma_f32_16x16x32_bf16 v[24:27], v[140:143], v[36:39], v[24:27]
    v_and_b32 v32, v212, v40
    v_and_b32 v33, v212, v41
    v_and_b32 v34, v212, v42
    v_and_b32 v35, v212, v43
    s_nop 1
    v_mfma_f32_16x16x32_bf16 v[24:27], v[144:147], v[32:35], v[24:27]
    v_and_b32 v36, v213, v40
    v_and_b32 v37, v213, v41
    v_and_b32 v38, v213, v42
    v_and_b32 v39, v213, v43
    s_nop 1
    v_mfma_f32_16x16x32_bf16 v[24:27], v[148:151], v[36:39], v[24:27]
    v_and_b32 v32, v214, v40
    v_and_b32 v33, v214, v41
    v_and_b32 v34, v214, v42
    v_and_b32 v35, v214, v43
    s_nop 1
    v_mfma_f32_16x16x32_bf16 v[24:27], v[152:155], v[32:35], v[24:27]
    v_and_b32 v36, v215, v40
    v_and_b32 v37, v215, v41
    v_and_b32 v38, v215, v42
    v_and_b32 v39, v215, v43
    s_nop 1
    v_mfma_f32_16x16x32_bf16 v[24:27], v[156:159], v[36:39], v[24:27]
    v_and_b32 v32, v216, v40
    v_and_b32 v33, v216, v41
    v_and_b32 v34, v216, v42
    v_and_b32 v35, v216, v43
    s_nop 1
    v_mfma_f32_16x16x32_bf16 v[24:27], v[160:163], v[32:35], v[24:27]
    v_and_b32 v36, v217, v40
    v_and_b32 v37, v217, v41
    v_and_b32 v38, v217, v42
    v_and_b32 v39, v217, v43
    s_nop 1
    v_mfma_f32_16x16x32_bf16 v[24:27], v[164:167], v[36:39], v[24:27]
    v_and_b32 v32, v218, v40
    v_and_b32 v33, v218, v41
    v_and_b32 v34, v218, v42
    v_and_b32 v35, v218, v43
    s_nop 1
    v_mfma_f32_16x16x32_bf16 v[24:27], v[168:171], v[32:35], v[24:27]
    v_and_b32 v36, v219, v40
    v_and_b32 v37, v219, v41
    v_and_b32 v38, v219, v42
    v_and_b32 v39, v219, v43
    s_nop 1
    v_mfma_f32_16x16x32_bf16 v[24:27], v[172:175], v[36:39], v[24:27]
    v_and_b32 v32, v220, v40
    v_and_b32 v33, v220, v41
    v_and_b32 v34, v220, v42
    v_and_b32 v35, v220, v43
    s_nop 1
    v_mfma_f32_16x16x32_bf16 v[24:27], v[176:179], v[32:35], v[24:27]
    v_and_b32 v36, v221, v40
    v_and_b32 v37, v221, v41
    v_and_b32 v38, v221, v42
    v_and_b32 v39, v221, v43
    s_nop 1
    v_mfma_f32_16x16x32_bf16 v[24:27], v[180:183], v[36:39], v[24:27]
    s_waitcnt lgkmcnt(0)
    s_and_b32 s77, s76, 0xff
    s_add_u32 s37, s77, 1
    s_cmp_eq_u32 s77, 0xff
    s_cselect_b32 s37, 1, s37
    v_mov_b32 v13, s37
    s_lshl_b32 s78, s78, 0
    s_add_u32 s78, s78, s7
    s_sub_u32 s78, s78, 832
    v_and_or_b32 v24, v24, s35, v13
    v_and_or_b32 v25, v25, s35, v13
    v_and_or_b32 v26, v26, s35, v13
    v_and_or_b32 v27, v27, s35, v13
    buffer_store_dwordx4 v[24:27], v44, s[68:71], s10 offen sc1
    s_lshl_b32 s10, s4, 12
    s_add_u32 s10, s10, 655360
    v_bfe_u32 v44, v1, 3, 2
    v_and_b32 v45, 7, v1
    v_lshl_add_u32 v44, v44, 5, v45
    v_lshlrev_b32 v44, 1, v44
    v_mov_b32 v45, 0
    v_mov_b32 v46, 1
    v_mov_b32 v47, s78
    ds_write_b32 v45, v47 offset:6096
    buffer_load_dwordx4 v[112:115], v4, s[68:71], s10 offen offset:0 sc1
    buffer_load_dwordx4 v[116:119], v4, s[68:71], s10 offen offset:1024 sc1
    buffer_load_dwordx4 v[120:123], v4, s[68:71], s10 offen offset:2048 sc1
    buffer_load_dwordx4 v[124:127], v4, s[68:71], s10 offen offset:3072 sc1
L_q_poll:
    s_waitcnt vmcnt(0)
    v_msad_u8 v40, v112, v13, 0
    v_msad_u8 v41, v113, v13, 0
    v_msad_u8 v42, v114, v13, 0
    v_msad_u8 v40, v115, v13, v40
    v_msad_u8 v41, v116, v13, v41
    v_msad_u8 v42, v117, v13, v42
    v_msad_u8 v40, v118, v13, v40
    v_msad_u8 v41, v119, v13, v41
    v_msad_u8 v42, v120, v13, v42
    v_msad_u8 v40, v121, v13, v40
    v_msad_u8 v41, v122, v13, v41
    v_msad_u8 v42, v123, v13, v42
    v_msad_u8 v40, v124, v13, v40
    v_msad_u8 v41, v125, v13, v41
    v_msad_u8 v42, v126, v13, v42
    v_msad_u8 v40, v127, v13, v40
    v_or3_b32 v40, v40, v41, v42
    v_cmp_ne_u32 vcc, 0, v40
    s_cbranch_vccz L_q_got0
    buffer_load_dwordx4 v[112:115], v4, s[68:71], s10 offen offset:0 sc1
    buffer_load_dwordx4 v[116:119], v4, s[68:71], s10 offen offset:1024 sc1
    buffer_load_dwordx4 v[120:123], v4, s[68:71], s10 offen offset:2048 sc1
    buffer_load_dwordx4 v[124:127], v4, s[68:71], s10 offen offset:3072 sc1
    s_add_u32 s91, s91, 1
    s_cmp_gt_u32 s91, 2000000
    s_cbranch_scc1 L_END
    s_branch L_q_poll
L_q_got0:
    v_pk_add_f32 v[24:25], v[112:113], v[116:117]
    v_pk_add_f32 v[32:33], v[120:121], v[124:125]
    v_pk_add_f32 v[26:27], v[114:115], v[118:119]
    v_pk_add_f32 v[34:35], v[122:123], v[126:127]
L_q_go:
    v_add_f32 v24, v24, v32
    v_add_f32 v25, v25, v33
    v_add_f32 v26, v26, v34
    v_add_f32 v27, v27, v35
    v_mov_b32 v28, v24
    v_mov_b32 v29, v25
    v_mov_b32 v30, v26
    v_mov_b32 v31, v27
    v_permlane32_swap_b32 v24, v28
    v_permlane32_swap_b32 v25, v29
    v_permlane32_swap_b32 v26, v30
    v_permlane32_swap_b32 v27, v31
    v_add_f32 v24, v24, v28
    v_add_f32 v25, v25, v29
    v_add_f32 v26, v26, v30
    v_add_f32 v27, v27, v31
    v_cvt_pk_bf16_f32 v24, v24, v25
    v_cvt_pk_bf16_f32 v26, v26, v27
    ds_write_b16 v44, v24 offset:4096
    ds_write_b16_d16_hi v44, v24 offset:4112
    ds_write_b16 v44, v26 offset:4128
    ds_write_b16_d16_hi v44, v26 offset:4144
    s_waitcnt lgkmcnt(0)
    ds_write_b32 v45, v46 offset:6092
    s_setprio 0
    s_add_u32 s38, s5, 28
    s_and_b32 s84, s38, 15
    s_lshl_b32 s9, s38, 12
    s_mul_i32 s84, s84, 3840
    s_sub_u32 s9, s9, s84
    buffer_load_dwordx4 v[48:51], v248, s[40:43], s9 offen nt
    buffer_load_dwordx4 v[52:55], v249, s[40:43], s9 offen nt
    buffer_load_dwordx4 v[56:59], v251, s[40:43], s9 offen nt
    buffer_load_dwordx4 v[60:63], v252, s[40:43], s9 offen nt
    buffer_load_dwordx4 v[64:67], v248, s[44:47], s9 offen nt
    buffer_load_dwordx4 v[68:71], v249, s[44:47], s9 offen nt
    buffer_load_dwordx4 v[72:75], v251, s[44:47], s9 offen nt
    buffer_load_dwordx4 v[76:79], v252, s[44:47], s9 offen nt
    s_branch L_wait_q
L_pace:
    s_waitcnt vmcnt(8)
    buffer_load_dwordx4 v[96:99], v248, s[44:47], s9 offen nt
    buffer_load_dwordx4 v[100:103], v249, s[44:47], s9 offen nt
    buffer_load_dwordx4 v[104:107], v251, s[44:47], s9 offen nt
    buffer_load_dwordx4 v[108:111], v252, s[44:47], s9 offen nt
    s_add_u32 s85, s85, 7
    s_and_b32 s84, s85, 15
    s_lshl_b32 s9, s85, 12
    s_mul_i32 s84, s84, 3840
    s_sub_u32 s9, s9, s84
    s_waitcnt vmcnt(8)
    buffer_load_dwordx4 v[112:115], v248, s[40:43], s9 offen nt
    buffer_load_dwordx4 v[116:119], v249, s[40:43], s9 offen nt
    buffer_load_dwordx4 v[120:123], v251, s[40:43], s9 offen nt
    buffer_load_dwordx4 v[124:127], v252, s[40:43], s9 offen nt
    s_waitcnt vmcnt(8)
    buffer_load_dwordx4 v[128:131], v248, s[44:47], s9 offen nt
    buffer_load_dwordx4 v[132:135], v249, s[44:47], s9 offen nt
    buffer_load_dwordx4 v[136:139], v251, s[44:47], s9 offen nt
    buffer_load_dwordx4 v[140:143], v252, s[44:47], s9 offen nt
    s_add_u32 s85, s85, 7
    s_and_b32 s84, s85, 15
    s_lshl_b32 s9, s85, 12
    s_mul_i32 s84, s84, 3840
    s_sub_u32 s9, s9, s84
    s_waitcnt vmcnt(8)
    buffer_load_dwordx4 v[144:147], v248, s[40:43], s9 offen nt
    buffer_load_dwordx4 v[148:151], v249, s[40:43], s9 offen nt
    buffer_load_dwordx4 v[152:155], v251, s[40:43], s9 offen nt
    buffer_load_dwordx4 v[156:159], v252, s[40:43], s9 offen nt
    s_waitcnt vmcnt(8)
    buffer_load_dwordx4 v[160:163], v248, s[44:47], s9 offen nt
    buffer_load_dwordx4 v[164:167], v249, s[44:47], s9 offen nt
    buffer_load_dwordx4 v[168:171], v251, s[44:47], s9 offen nt
    buffer_load_dwordx4 v[172:175], v252, s[44:47], s9 offen nt
    s_mov_b32 s38, 0
    s_mov_b32 s90, 1
    s_waitcnt lgkmcnt(0)
    s_and_b32 s77, s76, 0xff
    s_add_u32 s37, s77, 1
    s_cmp_eq_u32 s77, 0xff
    s_cselect_b32 s37, 1, s37
    v_mov_b32 v13, s37
L_wait_q:
    v_lshrrev_b32 v34, 3, v1
    v_mul_u32_u24 v34, 1152, v34
    v_and_b32 v35, 1, v2
    v_lshlrev_b32 v35, 1, v35
    v_and_b32 v32, 7, v1
    v_xor_b32 v32, v32, v35
    v_xor_b32 v33, 4, v32
    v_lshl_add_u32 v9, v32, 4, v34
    v_lshl_add_u32 v10, v33, 4, v34
    v_lshrrev_b32 v34, 3, v1
    v_mul_u32_u24 v34, 9216, v34
    v_and_b32 v36, 7, v1
    v_lshl_add_u32 v11, v36, 4, v34
    v_mov_b32 v12, 1
    v_mov_b32 v40, 0
    v_lshlrev_b32 v41, 4, v3
    v_mov_b32 v14, 0
    v_mov_b32 v15, 0
    v_mov_b32 v16, 0
    v_mov_b32 v17, 0
    v_mov_b32 v18, 0
    v_mov_b32 v19, 0
    v_mov_b32 v20, 0
    v_mov_b32 v21, 0
    v_mov_b32 v22, 0xff800000
    v_mov_b32 v23, 0
L_qw:
    ds_read_b32 v42, v40 offset:6092
    ds_read_b128 v[24:27], v41 offset:4096
    ds_read_b32 v43, v40 offset:6096
    s_waitcnt lgkmcnt(0)
    v_readfirstlane_b32 s10, v42
    s_mov_b32 s6, 0
    s_cmp_lt_u32 s1, s0
    s_cbranch_scc1 L_qw_gu
    s_cmp_lt_u32 s8, s33
    s_cselect_b32 s15, s11, 0
    s_cmp_eq_u32 s15, 1
    s_cbranch_scc1 L_qw_grp
    s_cmp_eq_u32 s10, 1
    s_cbranch_scc1 L_fl_got
    s_cmp_lt_u32 s1, 5
    s_cbranch_scc1 L_qw_gu
    s_branch L_qw_idle
L_qw_gu:
    s_add_u32 s36, s36, 1
    s_waitcnt vmcnt(4)
    s_branch L_gu
L_qw_grp:
    s_mov_b64 exec, 1
    s_waitcnt vmcnt(4)
    ds_add_rtn_u32 v42, v4, v12 offset:6084
    s_mov_b64 exec, -1
    s_waitcnt lgkmcnt(0)
    v_readfirstlane_b32 s8, v42
    s_cmp_ge_u32 s8, s33
    s_cbranch_scc1 L_qw
    s_add_u32 s36, s36, 1
    s_branch L_dma
L_qw_idle:
    s_sleep 1
    s_add_u32 s91, s91, 1
    s_cmp_gt_u32 s91, 2000000
    s_cbranch_scc1 L_END
    s_branch L_qw
L_fl_got:
    v_readfirstlane_b32 s78, v43
    v_mov_b32 v5, v24
    v_mov_b32 v6, v25
    v_mov_b32 v7, v26
    v_mov_b32 v8, v27
    s_cmp_eq_u32 s90, 0
    s_cbranch_scc1 L_qland
    s_mov_b64 exec, 1
    s_branch L_loop_nw
L_qland:
    s_cmp_ge_u32 s36, 2
    s_cbranch_scc1 L_landed
    s_waitcnt vmcnt(0)
L_landed:
    s_cmp_eq_u32 s90, 0
    s_cbranch_scc1 L_loop
    s_mov_b64 exec, 1
    s_cmp_eq_u32 s90, 0
    s_branch L_loop_nw
L_loop:
    s_mov_b64 exec, 1
    s_bitcmp1_b32 s38, 11
    s_waitcnt vmcnt(4)
L_loop_nw:
    ds_add_rtn_u32 v40, v4, v12 offset:6080
    v_readfirstlane_b32 s10, v42
    s_mov_b64 exec, -1
    s_cbranch_scc1 L_skipK
    v_dot2_f32_bf16 v24, v48, v5, 0
    v_dot2_f32_bf16 v25, v52, v5, 0
    v_dot2_f32_bf16 v26, v56, v5, 0
    v_dot2_f32_bf16 v27, v60, v5, 0
    v_dot2c_f32_bf16 v24, v49, v6
    v_dot2c_f32_bf16 v25, v53, v6
    v_dot2c_f32_bf16 v26, v57, v6
    v_dot2c_f32_bf16 v27, v61, v6
    v_dot2c_f32_bf16 v24, v50, v7
    v_dot2c_f32_bf16 v25, v54, v7
    v_dot2c_f32_bf16 v26, v58, v7
    v_dot2c_f32_bf16 v27, v62, v7
    v_dot2c_f32_bf16 v24, v51, v8
    v_dot2c_f32_bf16 v25, v55, v8
    v_dot2c_f32_bf16 v26, v59, v8
    v_dot2c_f32_bf16 v27, v63, v8
L_skipK:
    s_cmp_eq_u32 s90, 0
    s_cselect_b32 s32, 2, 0
    s_waitcnt lgkmcnt(0)
    v_readfirstlane_b32 s7, v40
    s_add_u32 s34, s7, s5
    s_cmp_lt_u32 s7, s14
    s_cbranch_scc1 L_st
    s_lshl_b32 s10, s10, 0
    s_sub_u32 s34, s10, s78
    s_cmp_eq_u32 s39, 0
    s_cselect_b32 s34, 2048, s34
    s_mov_b32 s39, 1
    s_bitcmp1_b32 s34, 10
    s_cselect_b32 s32, 2, 1
L_st:
    s_and_b32 s15, s34, 15
    s_lshl_b32 s9, s34, 12
    s_mul_i32 s15, s15, 3840
    s_sub_u32 s9, s9, s15
    buffer_load_dwordx4 v[48:51], v248, s[40:43], s9 offen nt
    buffer_load_dwordx4 v[52:55], v249, s[40:43], s9 offen nt
    buffer_load_dwordx4 v[56:59], v251, s[40:43], s9 offen nt
    buffer_load_dwordx4 v[60:63], v252, s[40:43], s9 offen nt
    s_cmp_eq_u32 s32, 1
    s_cbranch_scc0 L_noat
    v_mov_b32 v42, 1
    s_mov_b64 exec, 1
    buffer_atomic_add v42, v4, s[68:71], s79 offen sc0 sc1
    s_mov_b64 exec, -1
L_noat:
    s_bitcmp1_b32 s38, 11
    s_cbranch_scc1 L_skipV
    v_add_f32_dpp v24, v24, v24 row_ror:8 row_mask:0xf bank_mask:0xf
    v_add_f32_dpp v25, v25, v25 row_ror:8 row_mask:0xf bank_mask:0xf
    v_add_f32_dpp v26, v26, v26 row_ror:8 row_mask:0xf bank_mask:0xf
    v_add_f32_dpp v27, v27, v27 row_ror:8 row_mask:0xf bank_mask:0xf
    v_add_f32_dpp v24, v24, v24 row_ror:4 row_mask:0xf bank_mask:0xf
    v_add_f32_dpp v25, v25, v25 row_ror:4 row_mask:0xf bank_mask:0xf
    v_add_f32_dpp v26, v26, v26 row_ror:4 row_mask:0xf bank_mask:0xf
    v_add_f32_dpp v27, v27, v27 row_ror:4 row_mask:0xf bank_mask:0xf
    v_add_f32_dpp v24, v24, v24 row_ror:2 row_mask:0xf bank_mask:0xf
    v_add_f32_dpp v25, v25, v25 row_ror:2 row_mask:0xf bank_mask:0xf
    v_add_f32_dpp v26, v26, v26 row_ror:2 row_mask:0xf bank_mask:0xf
    v_add_f32_dpp v27, v27, v27 row_ror:2 row_mask:0xf bank_mask:0xf
    v_add_f32_dpp v24, v24, v24 row_ror:1 row_mask:0xf bank_mask:0xf
    v_add_f32_dpp v25, v25, v25 row_ror:1 row_mask:0xf bank_mask:0xf
    v_add_f32_dpp v26, v26, v26 row_ror:1 row_mask:0xf bank_mask:0xf
    v_add_f32_dpp v27, v27, v27 row_ror:1 row_mask:0xf bank_mask:0xf
    v_cvt_pk_bf16_f32 v28, v24, v25
    v_cvt_pk_bf16_f32 v29, v26, v27
    v_lshlrev_b32 v24, 16, v28
    v_and_b32 v25, 0xffff0000, v28
    v_lshlrev_b32 v26, 16, v29
    v_and_b32 v27, 0xffff0000, v29
    v_mul_f32 v24, s89, v24
    v_mul_f32 v25, s89, v25
    v_mul_f32 v26, s89, v26
    v_mul_f32 v27, s89, v27
    v_cvt_pk_bf16_f32 v28, v24, v25
    v_cvt_pk_bf16_f32 v29, v26, v27
    v_lshlrev_b32 v24, 16, v28
    v_and_b32 v25, 0xffff0000, v28
    v_lshlrev_b32 v26, 16, v29
    v_and_b32 v27, 0xffff0000, v29
    v_max3_f32 v30, v24, v25, v22
    v_max3_f32 v30, v26, v27, v30
    v_sub_f32 v31, v22, v30
    v_sub_f32 v24, v24, v30
    v_sub_f32 v25, v25, v30
    v_sub_f32 v26, v26, v30
    v_sub_f32 v27, v27, v30
    v_mul_f32 v31, s88, v31
    v_mul_f32 v24, s88, v24
    v_mul_f32 v25, s88, v25
    v_mul_f32 v26, s88, v26
    v_mul_f32 v27, s88, v27
    v_exp_f32 v31, v31
    v_exp_f32 v24, v24
    v_exp_f32 v25, v25
    v_exp_f32 v26, v26
    v_exp_f32 v27, v27
    v_mov_b32 v22, v30
    v_mul_f32 v14, v14, v31
    v_mul_f32 v15, v15, v31
    v_mul_f32 v16, v16, v31
    v_mul_f32 v17, v17, v31
    v_mul_f32 v18, v18, v31
    v_mul_f32 v19, v19, v31
    v_mul_f32 v20, v20, v31
    v_mul_f32 v21, v21, v31
    v_fma_f32 v23, v23, v31, v24
    v_add_f32 v30, v25, v26
    v_add_f32 v23, v23, v27
    v_cvt_pk_bf16_f32 v32, v24, 0
    v_cvt_pk_bf16_f32 v33, 0, v24
    v_cvt_pk_bf16_f32 v34, v25, 0
    v_cvt_pk_bf16_f32 v35, 0, v25
    v_cvt_pk_bf16_f32 v36, v26, 0
    v_cvt_pk_bf16_f32 v37, 0, v26
    v_cvt_pk_bf16_f32 v38, v27, 0
    v_cvt_pk_bf16_f32 v39, 0, v27
    v_add_f32 v23, v23, v30
    s_cmp_eq_u32 s32, 0
    s_cbranch_scc1 L_vw
    s_cmp_eq_u32 s32, 1
    s_waitcnt vmcnt(5)
    s_cbranch_scc1 L_vw
    s_waitcnt vmcnt(4)
L_vw:
    v_dot2c_f32_bf16 v14, v64, v32
    v_dot2c_f32_bf16 v15, v64, v33
    v_dot2c_f32_bf16 v16, v65, v32
    v_dot2c_f32_bf16 v17, v65, v33
    v_dot2c_f32_bf16 v18, v66, v32
    v_dot2c_f32_bf16 v19, v66, v33
    v_dot2c_f32_bf16 v20, v67, v32
    v_dot2c_f32_bf16 v21, v67, v33
    v_dot2c_f32_bf16 v14, v68, v34
    v_dot2c_f32_bf16 v15, v68, v35
    v_dot2c_f32_bf16 v16, v69, v34
    v_dot2c_f32_bf16 v17, v69, v35
    v_dot2c_f32_bf16 v18, v70, v34
    v_dot2c_f32_bf16 v19, v70, v35
    v_dot2c_f32_bf16 v20, v71, v34
    v_dot2c_f32_bf16 v21, v71, v35
    v_dot2c_f32_bf16 v14, v72, v36
    v_dot2c_f32_bf16 v15, v72, v37
    v_dot2c_f32_bf16 v16, v73, v36
    v_dot2c_f32_bf16 v17, v73, v37
    v_dot2c_f32_bf16 v18, v74, v36
    v_dot2c_f32_bf16 v19, v74, v37
    v_dot2c_f32_bf16 v20, v75, v36
    v_dot2c_f32_bf16 v21, v75, v37
    v_dot2c_f32_bf16 v14, v76, v38
    v_dot2c_f32_bf16 v15, v76, v39
    v_dot2c_f32_bf16 v16, v77, v38
    v_dot2c_f32_bf16 v17, v77, v39
    v_dot2c_f32_bf16 v18, v78, v38
    v_dot2c_f32_bf16 v19, v78, v39
    v_dot2c_f32_bf16 v20, v79, v38
    v_dot2c_f32_bf16 v21, v79, v39
L_skipV:
    s_bitcmp1_b32 s34, 10
    s_cbranch_scc1 L_tail
    s_mov_b32 s38, s34
    buffer_load_dwordx4 v[64:67], v248, s[44:47], s9 offen nt
    buffer_load_dwordx4 v[68:71], v249, s[44:47], s9 offen nt
    buffer_load_dwordx4 v[72:75], v251, s[44:47], s9 offen nt
    buffer_load_dwordx4 v[76:79], v252, s[44:47], s9 offen nt
    s_cmp_eq_u32 s90, 0
    s_cbranch_scc1 L_loop
    s_mov_b32 s90, 0
    v_dot2_f32_bf16 v24, v80, v5, 0
    v_dot2_f32_bf16 v25, v84, v5, 0
    v_dot2_f32_bf16 v26, v88, v5, 0
    v_dot2_f32_bf16 v27, v92, v5, 0
    v_dot2c_f32_bf16 v24, v81, v6
    v_dot2c_f32_bf16 v25, v85, v6
    v_dot2c_f32_bf16 v26, v89, v6
    v_dot2c_f32_bf16 v27, v93, v6
    v_dot2c_f32_bf16 v24, v82, v7
    v_dot2c_f32_bf16 v25, v86, v7
    v_dot2c_f32_bf16 v26, v90, v7
    v_dot2c_f32_bf16 v27, v94, v7
    v_dot2c_f32_bf16 v24, v83, v8
    v_dot2c_f32_bf16 v25, v87, v8
    v_dot2c_f32_bf16 v26, v91, v8
    v_dot2c_f32_bf16 v27, v95, v8
    v_add_f32_dpp v24, v24, v24 row_ror:8 row_mask:0xf bank_mask:0xf
    v_add_f32_dpp v25, v25, v25 row_ror:8 row_mask:0xf bank_mask:0xf
    v_add_f32_dpp v26, v26, v26 row_ror:8 row_mask:0xf bank_mask:0xf
    v_add_f32_dpp v27, v27, v27 row_ror:8 row_mask:0xf bank_mask:0xf
    v_add_f32_dpp v24, v24, v24 row_ror:4 row_mask:0xf bank_mask:0xf
    v_add_f32_dpp v25, v25, v25 row_ror:4 row_mask:0xf bank_mask:0xf
    v_add_f32_dpp v26, v26, v26 row_ror:4 row_mask:0xf bank_mask:0xf
    v_add_f32_dpp v27, v27, v27 row_ror:4 row_mask:0xf bank_mask:0xf
    v_add_f32_dpp v24, v24, v24 row_ror:2 row_mask:0xf bank_mask:0xf
    v_add_f32_dpp v25, v25, v25 row_ror:2 row_mask:0xf bank_mask:0xf
    v_add_f32_dpp v26, v26, v26 row_ror:2 row_mask:0xf bank_mask:0xf
    v_add_f32_dpp v27, v27, v27 row_ror:2 row_mask:0xf bank_mask:0xf
    v_add_f32_dpp v24, v24, v24 row_ror:1 row_mask:0xf bank_mask:0xf
    v_add_f32_dpp v25, v25, v25 row_ror:1 row_mask:0xf bank_mask:0xf
    v_add_f32_dpp v26, v26, v26 row_ror:1 row_mask:0xf bank_mask:0xf
    v_add_f32_dpp v27, v27, v27 row_ror:1 row_mask:0xf bank_mask:0xf
    v_cvt_pk_bf16_f32 v28, v24, v25
    v_cvt_pk_bf16_f32 v29, v26, v27
    v_lshlrev_b32 v24, 16, v28
    v_and_b32 v25, 0xffff0000, v28
    v_lshlrev_b32 v26, 16, v29
    v_and_b32 v27, 0xffff0000, v29
    v_mul_f32 v24, s89, v24
    v_mul_f32 v25, s89, v25
    v_mul_f32 v26, s89, v26
    v_mul_f32 v27, s89, v27
    v_cvt_pk_bf16_f32 v28, v24, v25
    v_cvt_pk_bf16_f32 v29, v26, v27
    v_lshlrev_b32 v24, 16, v28
    v_and_b32 v25, 0xffff0000, v28
    v_lshlrev_b32 v26, 16, v29
    v_and_b32 v27, 0xffff0000, v29
    v_max3_f32 v30, v24, v25, v22
    v_max3_f32 v30, v26, v27, v30
    v_sub_f32 v31, v22, v30
    v_sub_f32 v24, v24, v30
    v_sub_f32 v25, v25, v30
    v_sub_f32 v26, v26, v30
    v_sub_f32 v27, v27, v30
    v_mul_f32 v31, s88, v31
    v_mul_f32 v24, s88, v24
    v_mul_f32 v25, s88, v25
    v_mul_f32 v26, s88, v26
    v_mul_f32 v27, s88, v27
    v_exp_f32 v31, v31
    v_exp_f32 v24, v24
    v_exp_f32 v25, v25
    v_exp_f32 v26, v26
    v_exp_f32 v27, v27
    v_mov_b32 v22, v30
    v_mul_f32 v14, v14, v31
    v_mul_f32 v15, v15, v31
    v_mul_f32 v16, v16, v31
    v_mul_f32 v17, v17, v31
    v_mul_f32 v18, v18, v31
    v_mul_f32 v19, v19, v31
    v_mul_f32 v20, v20, v31
    v_mul_f32 v21, v21, v31
    v_fma_f32 v23, v23, v31, v24
    v_add_f32 v30, v25, v26
    v_add_f32 v23, v23, v27
    v_cvt_pk_bf16_f32 v32, v24, 0
    v_cvt_pk_bf16_f32 v33, 0, v24
    v_cvt_pk_bf16_f32 v34, v25, 0
    v_cvt_pk_bf16_f32 v35, 0, v25
    v_cvt_pk_bf16_f32 v36, v26, 0
    v_cvt_pk_bf16_f32 v37, 0, v26
    v_cvt_pk_bf16_f32 v38, v27, 0
    v_cvt_pk_bf16_f32 v39, 0, v27
    v_add_f32 v23, v23, v30
    v_dot2c_f32_bf16 v14, v96, v32
    v_dot2c_f32_bf16 v15, v96, v33
    v_dot2c_f32_bf16 v16, v97, v32
    v_dot2c_f32_bf16 v17, v97, v33
    v_dot2c_f32_bf16 v18, v98, v32
    v_dot2c_f32_bf16 v19, v98, v33
    v_dot2c_f32_bf16 v20, v99, v32
    v_dot2c_f32_bf16 v21, v99, v33
    v_dot2c_f32_bf16 v14, v100, v34
    v_dot2c_f32_bf16 v15, v100, v35
    v_dot2c_f32_bf16 v16, v101, v34
    v_dot2c_f32_bf16 v17, v101, v35
    v_dot2c_f32_bf16 v18, v102, v34
    v_dot2c_f32_bf16 v19, v102, v35
    v_dot2c_f32_bf16 v20, v103, v34
    v_dot2c_f32_bf16 v21, v103, v35
    v_dot2c_f32_bf16 v14, v104, v36
    v_dot2c_f32_bf16 v15, v104, v37
    v_dot2c_f32_bf16 v16, v105, v36
    v_dot2c_f32_bf16 v17, v105, v37
    v_dot2c_f32_bf16 v18, v106, v36
    v_dot2c_f32_bf16 v19, v106, v37
    v_dot2c_f32_bf16 v20, v107, v36
    v_dot2c_f32_bf16 v21, v107, v37
    v_dot2c_f32_bf16 v14, v108, v38
    v_dot2c_f32_bf16 v15, v108, v39
    v_dot2c_f32_bf16 v16, v109, v38
    v_dot2c_f32_bf16 v17, v109, v39
    v_dot2c_f32_bf16 v18, v110, v38
    v_dot2c_f32_bf16 v19, v110, v39
    v_dot2c_f32_bf16 v20, v111, v38
    v_dot2c_f32_bf16 v21, v111, v39
    v_dot2_f32_bf16 v24, v112, v5, 0
    v_dot2_f32_bf16 v25, v116, v5, 0
    v_dot2_f32_bf16 v26, v120, v5, 0
    v_dot2_f32_bf16 v27, v124, v5, 0
    v_dot2c_f32_bf16 v24, v113, v6
    v_dot2c_f32_bf16 v25, v117, v6
    v_dot2c_f32_bf16 v26, v121, v6
    v_dot2c_f32_bf16 v27, v125, v6
    v_dot2c_f32_bf16 v24, v114, v7
    v_dot2c_f32_bf16 v25, v118, v7
    v_dot2c_f32_bf16 v26, v122, v7
    v_dot2c_f32_bf16 v27, v126, v7
    v_dot2c_f32_bf16 v24, v115, v8
    v_dot2c_f32_bf16 v25, v119, v8
    v_dot2c_f32_bf16 v26, v123, v8
    v_dot2c_f32_bf16 v27, v127, v8
    v_add_f32_dpp v24, v24, v24 row_ror:8 row_mask:0xf bank_mask:0xf
    v_add_f32_dpp v25, v25, v25 row_ror:8 row_mask:0xf bank_mask:0xf
    v_add_f32_dpp v26, v26, v26 row_ror:8 row_mask:0xf bank_mask:0xf
    v_add_f32_dpp v27, v27, v27 row_ror:8 row_mask:0xf bank_mask:0xf
    v_add_f32_dpp v24, v24, v24 row_ror:4 row_mask:0xf bank_mask:0xf
    v_add_f32_dpp v25, v25, v25 row_ror:4 row_mask:0xf bank_mask:0xf
    v_add_f32_dpp v26, v26, v26 row_ror:4 row_mask:0xf bank_mask:0xf
    v_add_f32_dpp v27, v27, v27 row_ror:4 row_mask:0xf bank_mask:0xf
    v_add_f32_dpp v24, v24, v24 row_ror:2 row_mask:0xf bank_mask:0xf
    v_add_f32_dpp v25, v25, v25 row_ror:2 row_mask:0xf bank_mask:0xf
    v_add_f32_dpp v26, v26, v26 row_ror:2 row_mask:0xf bank_mask:0xf
    v_add_f32_dpp v27, v27, v27 row_ror:2 row_mask:0xf bank_mask:0xf
    v_add_f32_dpp v24, v24, v24 row_ror:1 row_mask:0xf bank_mask:0xf
    v_add_f32_dpp v25, v25, v25 row_ror:1 row_mask:0xf bank_mask:0xf
    v_add_f32_dpp v26, v26, v26 row_ror:1 row_mask:0xf bank_mask:0xf
    v_add_f32_dpp v27, v27, v27 row_ror:1 row_mask:0xf bank_mask:0xf
    v_cvt_pk_bf16_f32 v28, v24, v25
    v_cvt_pk_bf16_f32 v29, v26, v27
    v_lshlrev_b32 v24, 16, v28
    v_and_b32 v25, 0xffff0000, v28
    v_lshlrev_b32 v26, 16, v29
    v_and_b32 v27, 0xffff0000, v29
    v_mul_f32 v24, s89, v24
    v_mul_f32 v25, s89, v25
    v_mul_f32 v26, s89, v26
    v_mul_f32 v27, s89, v27
    v_cvt_pk_bf16_f32 v28, v24, v25
    v_cvt_pk_bf16_f32 v29, v26, v27
    v_lshlrev_b32 v24, 16, v28
    v_and_b32 v25, 0xffff0000, v28
    v_lshlrev_b32 v26, 16, v29
    v_and_b32 v27, 0xffff0000, v29
    v_max3_f32 v30, v24, v25, v22
    v_max3_f32 v30, v26, v27, v30
    v_sub_f32 v31, v22, v30
    v_sub_f32 v24, v24, v30
    v_sub_f32 v25, v25, v30
    v_sub_f32 v26, v26, v30
    v_sub_f32 v27, v27, v30
    v_mul_f32 v31, s88, v31
    v_mul_f32 v24, s88, v24
    v_mul_f32 v25, s88, v25
    v_mul_f32 v26, s88, v26
    v_mul_f32 v27, s88, v27
    v_exp_f32 v31, v31
    v_exp_f32 v24, v24
    v_exp_f32 v25, v25
    v_exp_f32 v26, v26
    v_exp_f32 v27, v27
    v_mov_b32 v22, v30
    v_mul_f32 v14, v14, v31
    v_mul_f32 v15, v15, v31
    v_mul_f32 v16, v16, v31
    v_mul_f32 v17, v17, v31
    v_mul_f32 v18, v18, v31
    v_mul_f32 v19, v19, v31
    v_mul_f32 v20, v20, v31
    v_mul_f32 v21, v21, v31
    v_fma_f32 v23, v23, v31, v24
    v_add_f32 v30, v25, v26
    v_add_f32 v23, v23, v27
    v_cvt_pk_bf16_f32 v32, v24, 0
    v_cvt_pk_bf16_f32 v33, 0, v24
    v_cvt_pk_bf16_f32 v34, v25, 0
    v_cvt_pk_bf16_f32 v35, 0, v25
    v_cvt_pk_bf16_f32 v36, v26, 0
    v_cvt_pk_bf16_f32 v37, 0, v26
    v_cvt_pk_bf16_f32 v38, v27, 0
    v_cvt_pk_bf16_f32 v39, 0, v27
    v_add_f32 v23, v23, v30
    s_cmp_ge_u32 s36, 2
    s_cbranch_scc1 L_fw5
    s_waitcnt vmcnt(16)
L_fw5:
    v_dot2c_f32_bf16 v14, v128, v32
    v_dot2c_f32_bf16 v15, v128, v33
    v_dot2c_f32_bf16 v16, v129, v32
    v_dot2c_f32_bf16 v17, v129, v33
    v_dot2c_f32_bf16 v18, v130, v32
    v_dot2c_f32_bf16 v19, v130, v33
    v_dot2c_f32_bf16 v20, v131, v32
    v_dot2c_f32_bf16 v21, v131, v33
    v_dot2c_f32_bf16 v14, v132, v34
    v_dot2c_f32_bf16 v15, v132, v35
    v_dot2c_f32_bf16 v16, v133, v34
    v_dot2c_f32_bf16 v17, v133, v35
    v_dot2c_f32_bf16 v18, v134, v34
    v_dot2c_f32_bf16 v19, v134, v35
    v_dot2c_f32_bf16 v20, v135, v34
    v_dot2c_f32_bf16 v21, v135, v35
    v_dot2c_f32_bf16 v14, v136, v36
    v_dot2c_f32_bf16 v15, v136, v37
    v_dot2c_f32_bf16 v16, v137, v36
    v_dot2c_f32_bf16 v17, v137, v37
    v_dot2c_f32_bf16 v18, v138, v36
    v_dot2c_f32_bf16 v19, v138, v37
    v_dot2c_f32_bf16 v20, v139, v36
    v_dot2c_f32_bf16 v21, v139, v37
    v_dot2c_f32_bf16 v14, v140, v38
    v_dot2c_f32_bf16 v15, v140, v39
    v_dot2c_f32_bf16 v16, v141, v38
    v_dot2c_f32_bf16 v17, v141, v39
    v_dot2c_f32_bf16 v18, v142, v38
    v_dot2c_f32_bf16 v19, v142, v39
    v_dot2c_f32_bf16 v20, v143, v38
    v_dot2c_f32_bf16 v21, v143, v39
    s_cmp_ge_u32 s36, 2
    s_cbranch_scc1 L_fw6
    s_waitcnt vmcnt(12)
L_fw6:
    v_dot2_f32_bf16 v24, v144, v5, 0
    v_dot2_f32_bf16 v25, v148, v5, 0
    v_dot2_f32_bf16 v26, v152, v5, 0
    v_dot2_f32_bf16 v27, v156, v5, 0
    v_dot2c_f32_bf16 v24, v145, v6
    v_dot2c_f32_bf16 v25, v149, v6
    v_dot2c_f32_bf16 v26, v153, v6
    v_dot2c_f32_bf16 v27, v157, v6
    v_dot2c_f32_bf16 v24, v146, v7
    v_dot2c_f32_bf16 v25, v150, v7
    v_dot2c_f32_bf16 v26, v154, v7
    v_dot2c_f32_bf16 v27, v158, v7
    v_dot2c_f32_bf16 v24, v147, v8
    v_dot2c_f32_bf16 v25, v151, v8
    v_dot2c_f32_bf16 v26, v155, v8
    v_dot2c_f32_bf16 v27, v159, v8
    v_add_f32_dpp v24, v24, v24 row_ror:8 row_mask:0xf bank_mask:0xf
    v_add_f32_dpp v25, v25, v25 row_ror:8 row_mask:0xf bank_mask:0xf
    v_add_f32_dpp v26, v26, v26 row_ror:8 row_mask:0xf bank_mask:0xf
    v_add_f32_dpp v27, v27, v27 row_ror:8 row_mask:0xf bank_mask:0xf
    v_add_f32_dpp v24, v24, v24 row_ror:4 row_mask:0xf bank_mask:0xf
    v_add_f32_dpp v25, v25, v25 row_ror:4 row_mask:0xf bank_mask:0xf
    v_add_f32_dpp v26, v26, v26 row_ror:4 row_mask:0xf bank_mask:0xf
    v_add_f32_dpp v27, v27, v27 row_ror:4 row_mask:0xf bank_mask:0xf
    v_add_f32_dpp v24, v24, v24 row_ror:2 row_mask:0xf bank_mask:0xf
    v_add_f32_dpp v25, v25, v25 row_ror:2 row_mask:0xf bank_mask:0xf
    v_add_f32_dpp v26, v26, v26 row_ror:2 row_mask:0xf bank_mask:0xf
    v_add_f32_dpp v27, v27, v27 row_ror:2 row_mask:0xf bank_mask:0xf
    v_add_f32_dpp v24, v24, v24 row_ror:1 row_mask:0xf bank_mask:0xf
    v_add_f32_dpp v25, v25, v25 row_ror:1 row_mask:0xf bank_mask:0xf
    v_add_f32_dpp v26, v26, v26 row_ror:1 row_mask:0xf bank_mask:0xf
    v_add_f32_dpp v27, v27, v27 row_ror:1 row_mask:0xf bank_mask:0xf
    v_cvt_pk_bf16_f32 v28, v24, v25
    v_cvt_pk_bf16_f32 v29, v26, v27
    v_lshlrev_b32 v24, 16, v28
    v_and_b32 v25, 0xffff0000, v28
    v_lshlrev_b32 v26, 16, v29
    v_and_b32 v27, 0xffff0000, v29
    v_mul_f32 v24, s89, v24
    v_mul_f32 v25, s89, v25
    v_mul_f32 v26, s89, v26
    v_mul_f32 v27, s89, v27
    v_cvt_pk_bf16_f32 v28, v24, v25
    v_cvt_pk_bf16_f32 v29, v26, v27
    v_lshlrev_b32 v24, 16, v28
    v_and_b32 v25, 0xffff0000, v28
    v_lshlrev_b32 v26, 16, v29
    v_and_b32 v27, 0xffff0000, v29
    v_max3_f32 v30, v24, v25, v22
    v_max3_f32 v30, v26, v27, v30
    v_sub_f32 v31, v22, v30
    v_sub_f32 v24, v24, v30
    v_sub_f32 v25, v25, v30
    v_sub_f32 v26, v26, v30
    v_sub_f32 v27, v27, v30
    v_mul_f32 v31, s88, v31
    v_mul_f32 v24, s88, v24
    v_mul_f32 v25, s88, v25
    v_mul_f32 v26, s88, v26
    v_mul_f32 v27, s88, v27
    v_exp_f32 v31, v31
    v_exp_f32 v24, v24
    v_exp_f32 v25, v25
    v_exp_f32 v26, v26
    v_exp_f32 v27, v27
    v_mov_b32 v22, v30
    v_mul_f32 v14, v14, v31
    v_mul_f32 v15, v15, v31
    v_mul_f32 v16, v16, v31
    v_mul_f32 v17, v17, v31
    v_mul_f32 v18, v18, v31
    v_mul_f32 v19, v19, v31
    v_mul_f32 v20, v20, v31
    v_mul_f32 v21, v21, v31
    v_fma_f32 v23, v23, v31, v24
    v_add_f32 v30, v25, v26
    v_add_f32 v23, v23, v27
    v_cvt_pk_bf16_f32 v32, v24, 0
    v_cvt_pk_bf16_f32 v33, 0, v24
    v_cvt_pk_bf16_f32 v34, v25, 0
    v_cvt_pk_bf16_f32 v35, 0, v25
    v_cvt_pk_bf16_f32 v36, v26, 0
    v_cvt_pk_bf16_f32 v37, 0, v26
    v_cvt_pk_bf16_f32 v38, v27, 0
    v_cvt_pk_bf16_f32 v39, 0, v27
    v_add_f32 v23, v23, v30
    s_cmp_ge_u32 s36, 2
    s_cbranch_scc1 L_fw7
    s_waitcnt vmcnt(8)
L_fw7:
    v_dot2c_f32_bf16 v14, v160, v32
    v_dot2c_f32_bf16 v15, v160, v33
    v_dot2c_f32_bf16 v16, v161, v32
    v_dot2c_f32_bf16 v17, v161, v33
    v_dot2c_f32_bf16 v18, v162, v32
    v_dot2c_f32_bf16 v19, v162, v33
    v_dot2c_f32_bf16 v20, v163, v32
    v_dot2c_f32_bf16 v21, v163, v33
    v_dot2c_f32_bf16 v14, v164, v34
    v_dot2c_f32_bf16 v15, v164, v35
    v_dot2c_f32_bf16 v16, v165, v34
    v_dot2c_f32_bf16 v17, v165, v35
    v_dot2c_f32_bf16 v18, v166, v34
    v_dot2c_f32_bf16 v19, v166, v35
    v_dot2c_f32_bf16 v20, v167, v34
    v_dot2c_f32_bf16 v21, v167, v35
    v_dot2c_f32_bf16 v14, v168, v36
    v_dot2c_f32_bf16 v15, v168, v37
    v_dot2c_f32_bf16 v16, v169, v36
    v_dot2c_f32_bf16 v17, v169, v37
    v_dot2c_f32_bf16 v18, v170, v36
    v_dot2c_f32_bf16 v19, v170, v37
    v_dot2c_f32_bf16 v20, v171, v36
    v_dot2c_f32_bf16 v21, v171, v37
    v_dot2c_f32_bf16 v14, v172, v38
    v_dot2c_f32_bf16 v15, v172, v39
    v_dot2c_f32_bf16 v16, v173, v38
    v_dot2c_f32_bf16 v17, v173, v39
    v_dot2c_f32_bf16 v18, v174, v38
    v_dot2c_f32_bf16 v19, v174, v39
    v_dot2c_f32_bf16 v20, v175, v38
    v_dot2c_f32_bf16 v21, v175, v39
    s_branch L_loop
L_gu:
    s_mul_i32 s10, s3, 9
    s_lshl_b32 s15, s1, 1
    s_add_u32 s10, s10, s15
    s_mul_i32 s10, s10, 73728
    s_lshl_b32 s15, s12, 7
    s_add_u32 s10, s10, s15
    s_add_u32 s15, s10, 73728
    s_add_u32 s1, s1, 1
    s_cmp_eq_u32 s1, 1
    s_cbranch_scc0 L_gu1
    buffer_load_dwordx4 v[176:179], v11, s[60:63], s10 offen nt
    buffer_load_dwordx4 v[180:183], v11, s[64:67], s10 offen nt
    buffer_load_dwordx4 v[184:187], v11, s[60:63], s15 offen nt
    buffer_load_dwordx4 v[188:191], v11, s[64:67], s15 offen nt
    s_branch L_dg_next
L_gu1:
    s_cmp_eq_u32 s1, 2
    s_cbranch_scc0 L_gu2
    buffer_load_dwordx4 v[192:195], v11, s[60:63], s10 offen nt
    buffer_load_dwordx4 v[196:199], v11, s[64:67], s10 offen nt
    buffer_load_dwordx4 v[200:203], v11, s[60:63], s15 offen nt
    buffer_load_dwordx4 v[204:207], v11, s[64:67], s15 offen nt
    s_branch L_dg_next
L_gu2:
    s_cmp_eq_u32 s1, 3
    s_cbranch_scc0 L_gu3
    buffer_load_dwordx4 v[208:211], v11, s[60:63], s10 offen nt
    buffer_load_dwordx4 v[212:215], v11, s[64:67], s10 offen nt
    buffer_load_dwordx4 v[216:219], v11, s[60:63], s15 offen nt
    buffer_load_dwordx4 v[220:223], v11, s[64:67], s15 offen nt
    s_branch L_dg_next
L_gu3:
    s_cmp_eq_u32 s1, 4
    s_cbranch_scc0 L_gu4
    buffer_load_dwordx4 v[224:227], v11, s[60:63], s10 offen nt
    buffer_load_dwordx4 v[228:231], v11, s[64:67], s10 offen nt
    buffer_load_dwordx4 v[232:235], v11, s[60:63], s15 offen nt
    buffer_load_dwordx4 v[236:239], v11, s[64:67], s15 offen nt
    s_branch L_dg_next
L_gu4:
    buffer_load_dwordx4 v[240:243], v11, s[60:63], s10 offen nt
    buffer_load_dwordx4 v[244:247], v11, s[64:67], s10 offen nt
    s_branch L_dg_next
L_dma:
    s_lshl_b32 s15, s8, 12
    s_add_u32 s15, s15, 20480
    s_mov_b32 s87, 0x20000
    s_cmp_eq_u32 s11, 1
    s_cbranch_scc0 L_dg_D
    s_mov_b32 s84, s56
    s_mov_b32 s85, s57
    s_mov_b32 s86, 4718592
    s_lshl_b32 s10, s12, 4
    s_add_u32 s10, s10, s8
    s_mul_i32 s10, s10, 36864
    s_lshl_b32 s9, s13, 7
    s_add_u32 s10, s10, s9
    s_branch L_dg_P
L_dg_D:
    s_mov_b32 s84, s80
    s_mov_b32 s85, s81
    s_mov_b32 s86, 5308416
    s_mul_i32 s10, s12, 73728
    s_lshl_b32 s9, s8, 7
    s_add_u32 s10, s10, s9
    s_cmp_ge_u32 s8, 9
    s_cselect_b32 s9, 36864 - 1152, 0
    s_add_u32 s10, s10, s9
L_dg_P:
    s_mov_b32 m0, s15
    s_nop 0
    buffer_load_dwordx4 v9, s[84:87], s10 offen nt lds
    s_add_u32 s10, s10, 9216
    s_add_u32 s15, s15, 1024
    s_mov_b32 m0, s15
    s_nop 0
    buffer_load_dwordx4 v10, s[84:87], s10 offen nt lds
    s_add_u32 s10, s10, 9216
    s_add_u32 s15, s15, 1024
    s_mov_b32 m0, s15
    s_nop 0
    buffer_load_dwordx4 v9, s[84:87], s10 offen nt lds
    s_add_u32 s10, s10, 9216
    s_add_u32 s15, s15, 1024
    s_mov_b32 m0, s15
    s_nop 0
    buffer_load_dwordx4 v10, s[84:87], s10 offen nt lds
L_dg_next:
    s_cmp_eq_u32 s6, 0
    s_cbranch_scc1 L_qw
    s_branch L_we2
L_tail:
    s_mov_b32 s91, 0
    s_nop 3
    v_mov_b32 v24, v22
    v_mov_b32 v25, v22
    s_nop 1
    v_permlane16_swap_b32 v24, v25
    v_max_f32 v24, v24, v25
    v_mov_b32 v25, v24
    s_nop 1
    v_permlane32_swap_b32 v24, v25
    v_max_f32 v24, v24, v25
    v_sub_f32 v26, v22, v24
    v_mul_f32 v26, s88, v26
    v_exp_f32 v26, v26
    s_nop 0
    v_mul_f32 v14, v14, v26
    v_mul_f32 v15, v15, v26
    v_mul_f32 v16, v16, v26
    v_mul_f32 v17, v17, v26
    v_mul_f32 v18, v18, v26
    v_mul_f32 v19, v19, v26
    v_mul_f32 v20, v20, v26
    v_mul_f32 v21, v21, v26
    v_mul_f32 v25, v23, v26
    v_permlane32_swap_b32 v14, v18
    v_permlane32_swap_b32 v15, v19
    v_permlane32_swap_b32 v16, v20
    v_permlane32_swap_b32 v17, v21
    v_mov_b32 v27, v25
    s_nop 1
    v_permlane16_swap_b32 v25, v27
    v_add_f32 v14, v14, v18
    v_add_f32 v15, v15, v19
    v_add_f32 v16, v16, v20
    v_add_f32 v17, v17, v21
    v_add_f32 v25, v25, v27
    v_permlane16_swap_b32 v14, v16
    v_permlane16_swap_b32 v15, v17
    v_mov_b32 v27, v25
    s_nop 1
    v_permlane32_swap_b32 v25, v27
    v_add_f32 v14, v14, v16
    v_add_f32 v15, v15, v17
    v_add_f32 v25, v25, v27
    v_lshlrev_b32 v40, 5, v3
    v_lshl_add_u32 v40, v2, 3, v40
    s_lshl_b32 s10, s3, 9
    v_add_u32 v40, s10, v40
    ds_write_b64 v40, v[14:15] offset:0
    s_lshl_b32 s10, s3, 3
    v_mov_b32 v41, s10
    s_mov_b64 exec, 1
    ds_write_b64 v41, v[24:25] offset:4352
    ds_add_rtn_u32 v41, v4, v12 offset:6088
    s_mov_b64 exec, -1
    v_lshlrev_b32 v40, 3, v1
    v_mov_b32 v46, 0
    s_waitcnt lgkmcnt(0)
    v_readfirstlane_b32 s10, v41
    s_cmp_eq_u32 s10, 7
    s_cbranch_scc0 L_comb_skip
    ds_read_b128 v[24:27], v46 offset:4352
    ds_read_b128 v[28:31], v46 offset:4368
    ds_read_b128 v[32:35], v46 offset:4384
    ds_read_b128 v[36:39], v46 offset:4400
    ds_read_b64 v[80:81], v40 offset:0
    ds_read_b64 v[82:83], v40 offset:512
    ds_read_b64 v[84:85], v40 offset:1024
    ds_read_b64 v[86:87], v40 offset:1536
    ds_read_b64 v[88:89], v40 offset:2048
    ds_read_b64 v[90:91], v40 offset:2560
    ds_read_b64 v[92:93], v40 offset:3072
    ds_read_b64 v[94:95], v40 offset:3584
    s_waitcnt lgkmcnt(8)
    v_max3_f32 v42, v24, v26, v28
    v_max3_f32 v42, v30, v32, v42
    v_max3_f32 v42, v34, v36, v42
    v_max_f32 v42, v38, v42
    v_sub_f32 v24, v24, v42
    v_sub_f32 v26, v26, v42
    v_sub_f32 v28, v28, v42
    v_sub_f32 v30, v30, v42
    v_sub_f32 v32, v32, v42
    v_sub_f32 v34, v34, v42
    v_sub_f32 v36, v36, v42
    v_sub_f32 v38, v38, v42
    v_mul_f32 v24, s88, v24
    v_mul_f32 v26, s88, v26
    v_mul_f32 v28, s88, v28
    v_mul_f32 v30, s88, v30
    v_mul_f32 v32, s88, v32
    v_mul_f32 v34, s88, v34
    v_mul_f32 v36, s88, v36
    v_mul_f32 v38, s88, v38
    v_exp_f32 v24, v24
    v_exp_f32 v26, v26
    v_exp_f32 v28, v28
    v_exp_f32 v30, v30
    v_exp_f32 v32, v32
    v_exp_f32 v34, v34
    v_exp_f32 v36, v36
    v_exp_f32 v38, v38
    s_waitcnt lgkmcnt(0)
    v_mul_f32 v44, v24, v80
    v_mul_f32 v45, v24, v81
    v_mul_f32 v43, v24, v25
    v_fmac_f32 v44, v26, v82
    v_fmac_f32 v45, v26, v83
    v_fmac_f32 v43, v26, v27
    v_fmac_f32 v44, v28, v84
    v_fmac_f32 v45, v28, v85
    v_fmac_f32 v43, v28, v29
    v_fmac_f32 v44, v30, v86
    v_fmac_f32 v45, v30, v87
    v_fmac_f32 v43, v30, v31
    v_fmac_f32 v44, v32, v88
    v_fmac_f32 v45, v32, v89
    v_fmac_f32 v43, v32, v33
    v_fmac_f32 v44, v34, v90
    v_fmac_f32 v45, v34, v91
    v_fmac_f32 v43, v34, v35
    v_fmac_f32 v44, v36, v92
    v_fmac_f32 v45, v36, v93
    v_fmac_f32 v43, v36, v37
    v_fmac_f32 v44, v38, v94
    v_fmac_f32 v45, v38, v95
    v_fmac_f32 v43, v38, v39
    v_and_or_b32 v44, v44, s35, v13
    v_and_or_b32 v45, v45, s35, v13
    v_and_or_b32 v42, v42, s35, v13
    v_and_or_b32 v43, v43, s35, v13
    s_lshl_b32 s10, s2, 9
    buffer_store_dwordx2 v[44:45], v40, s[68:71], s10 offen sc1
    s_lshl_b32 s10, s2, 7
    s_add_u32 s10, s10, 131072
    s_mov_b64 exec, 1
    v_mov_b32 v36, v42
    v_mov_b32 v37, v43
    v_mov_b32 v38, v42
    v_mov_b32 v39, v43
    buffer_store_dwordx4 v[36:39], v46, s[68:71], s10 offen sc1
    s_mov_b64 exec, -1
L_comb_skip:
    s_cmp_eq_u32 s11, 0
    s_cbranch_scc0 L_nod
    s_cmp_lt_u32 s10, 7
    s_cbranch_scc0 L_nosl
    s_sleep 15
    s_cmp_lt_u32 s10, 5
    s_cbranch_scc0 L_nosl
    s_sleep 15
    s_cmp_lt_u32 s10, 3
    s_cbranch_scc0 L_nosl
    s_sleep 15
L_nosl:
    s_mov_b32 s33, 0
    s_mul_i32 s10, s12, 73728
    s_mul_i32 s15, s3, 9216
    s_add_u32 s10, s10, s15
    s_lshr_b32 s15, s3, 2
    s_mul_i32 s15, s15, 36864
    s_and_b32 s9, s3, 3
    s_lshl_b32 s9, s9, 10
    s_add_u32 s15, s15, s9
    s_add_u32 s15, s15, 20480
    s_bitcmp1_b32 s3, 0
    s_cselect_b64 vcc, -1, 0
    v_cndmask_b32 v40, v9, v10, vcc
    s_mov_b32 m0, s15
    s_nop 0
    buffer_load_dwordx4 v40, s[80:83], s10 offen nt lds
    s_add_u32 s10, s10, 128
    s_add_u32 s15, s15, 4096
    s_mov_b32 m0, s15
    s_nop 0
    buffer_load_dwordx4 v40, s[80:83], s10 offen nt lds
    s_add_u32 s10, s10, 128
    s_add_u32 s15, s15, 4096
    s_mov_b32 m0, s15
    s_nop 0
    buffer_load_dwordx4 v40, s[80:83], s10 offen nt lds
    s_add_u32 s10, s10, 128
    s_add_u32 s15, s15, 4096
    s_mov_b32 m0, s15
    s_nop 0
    buffer_load_dwordx4 v40, s[80:83], s10 offen nt lds
    s_add_u32 s10, s10, 128
    s_add_u32 s15, s15, 4096
    s_mov_b32 m0, s15
    s_nop 0
    buffer_load_dwordx4 v40, s[80:83], s10 offen nt lds
    s_add_u32 s10, s10, 128
    s_add_u32 s15, s15, 4096
    s_mov_b32 m0, s15
    s_nop 0
    buffer_load_dwordx4 v40, s[80:83], s10 offen nt lds
    s_add_u32 s10, s10, 128
    s_add_u32 s15, s15, 4096
    s_mov_b32 m0, s15
    s_nop 0
    buffer_load_dwordx4 v40, s[80:83], s10 offen nt lds
    s_add_u32 s10, s10, 128
    s_add_u32 s15, s15, 4096
    s_mov_b32 m0, s15
    s_nop 0
    buffer_load_dwordx4 v40, s[80:83], s10 offen nt lds
    s_add_u32 s10, s10, 128
    s_add_u32 s15, s15, 4096
    s_mov_b32 m0, s15
    s_nop 0
    buffer_load_dwordx4 v40, s[80:83], s10 offen nt lds
L_nod:
    s_mov_b32 s6, 1
L_we:
    s_cmp_lt_u32 s1, 5
    s_cbranch_scc1 L_gu
    s_cmp_ge_u32 s8, s33
    s_cbranch_scc1 L_wdone
    s_mov_b64 exec, 1
    ds_add_rtn_u32 v42, v4, v12 offset:6084
    s_mov_b64 exec, -1
    s_waitcnt lgkmcnt(0)
    v_readfirstlane_b32 s8, v42
    s_cmp_lt_u32 s8, s33
    s_cbranch_scc1 L_dma
    s_branch L_wdone
L_we2:
    s_waitcnt vmcnt(4)
    s_branch L_we
L_wdone:
    s_cmp_eq_u32 s11, 0
    s_cbranch_scc0 L_nocs
    v_and_b32 v24, 1, v1
    v_mov_b32 v25, 0xffff
    v_mov_b32 v26, 0xffff0000
    v_cmp_eq_u32 vcc, 1, v24
    s_nop 1
    v_cndmask_b32 v25, v25, v26, vcc
    v_bfe_u32 v24, v1, 1, 2
    v_cmp_eq_u32 vcc, 0, v24
    s_nop 1
    v_cndmask_b32 v88, 0, v25, vcc
    v_cmp_eq_u32 vcc, 1, v24
    s_nop 1
    v_cndmask_b32 v89, 0, v25, vcc
    v_cmp_eq_u32 vcc, 2, v24
    s_nop 1
    v_cndmask_b32 v90, 0, v25, vcc
    v_cmp_eq_u32 vcc, 3, v24
    s_nop 1
    v_cndmask_b32 v91, 0, v25, vcc
    v_and_b32 v32, 0x3f803f80, v88
    v_and_b32 v33, 0x3f803f80, v89
    v_and_b32 v34, 0x3f803f80, v90
    v_and_b32 v35, 0x3f803f80, v91
    v_and_b32 v41, 7, v1
    v_lshl_add_u32 v94, v2, 3, v41
    v_lshlrev_b32 v94, 4, v94
    v_bfe_u32 v40, v1, 3, 1
    v_mul_u32_u24 v97, 2176, v40
    v_add_u32 v97, v97, v94
    s_mul_i32 s15, s3, 544
    v_add_u32 v94, s15, v94
    v_mfma_f32_16x16x32_bf16 v[24:27], v[176:179], v[32:35], 0
    v_mfma_f32_16x16x32_bf16 v[28:31], v[180:183], v[32:35], 0
    v_mfma_f32_16x16x32_bf16 v[24:27], v[184:187], v[32:35], v[24:27]
    v_mfma_f32_16x16x32_bf16 v[28:31], v[188:191], v[32:35], v[28:31]
    v_mfma_f32_16x16x32_bf16 v[24:27], v[192:195], v[32:35], v[24:27]
    v_mfma_f32_16x16x32_bf16 v[28:31], v[196:199], v[32:35], v[28:31]
    v_mfma_f32_16x16x32_bf16 v[24:27], v[200:203], v[32:35], v[24:27]
    v_mfma_f32_16x16x32_bf16 v[28:31], v[204:207], v[32:35], v[28:31]
    v_mfma_f32_16x16x32_bf16 v[24:27], v[208:211], v[32:35], v[24:27]
    v_mfma_f32_16x16x32_bf16 v[28:31], v[212:215], v[32:35], v[28:31]
    v_mfma_f32_16x16x32_bf16 v[24:27], v[216:219], v[32:35], v[24:27]
    v_mfma_f32_16x16x32_bf16 v[28:31], v[220:223], v[32:35], v[28:31]
    v_mfma_f32_16x16x32_bf16 v[24:27], v[224:227], v[32:35], v[24:27]
    v_mfma_f32_16x16x32_bf16 v[28:31], v[228:231], v[32:35], v[28:31]
    v_mfma_f32_16x16x32_bf16 v[24:27], v[232:235], v[32:35], v[24:27]
    v_mfma_f32_16x16x32_bf16 v[28:31], v[236:239], v[32:35], v[28:31]
    v_mfma_f32_16x16x32_bf16 v[24:27], v[240:243], v[32:35], v[24:27]
    v_mfma_f32_16x16x32_bf16 v[28:31], v[244:247], v[32:35], v[28:31]
    s_nop 7
    v_permlane32_swap_b32 v24, v28
    v_permlane32_swap_b32 v25, v29
    v_permlane32_swap_b32 v26, v30
    v_permlane32_swap_b32 v27, v31
    v_add_f32_dpp v24, v28, v24 row_ror:8 row_mask:0xf bank_mask:0xf
    v_add_f32_dpp v25, v29, v25 row_ror:8 row_mask:0xf bank_mask:0xf
    v_add_f32_dpp v26, v30, v26 row_ror:8 row_mask:0xf bank_mask:0xf
    v_add_f32_dpp v27, v31, v27 row_ror:8 row_mask:0xf bank_mask:0xf
    s_mov_b32 exec_lo, 0x00ff00ff
    s_mov_b32 exec_hi, 0x00ff00ff
    ds_write_b128 v94, v[24:27] offset:14848
    s_mov_b64 exec, -1
    s_branch L_roleB
L_nocs:
    s_waitcnt vmcnt(0) lgkmcnt(0)
    s_barrier
    v_bfe_u32 v45, v1, 2, 2
    v_and_b32 v46, 3, v1
    s_cmp_eq_u32 s11, 0
    s_cbranch_scc1 L_roleB
    s_cmp_eq_u32 s11, 1
    s_cbranch_scc1 L_roleA
    s_cmp_eq_u32 s11, 2
    s_cbranch_scc1 L_roleC
    s_branch L_FIN
L_roleA:
    s_nop 3
    s_lshl_b32 s10, s12, 2
    s_lshr_b32 s15, s3, 1
    s_add_u32 s10, s10, s15
    s_lshl_b32 s15, s10, 10
    s_add_u32 s15, s15, 131072
    s_lshl_b32 s10, s10, 12
    s_and_b32 s84, s3, 1
    s_lshl_b32 s84, s84, 8
    s_add_u32 s10, s10, s84
    v_lshlrev_b32 v40, 9, v2
    v_lshl_add_u32 v40, v3, 4, v40
    v_bfe_u32 v41, v1, 1, 2
    v_add_u32 v41, v41, v2
    v_and_b32 v41, 3, v41
    v_and_b32 v42, 1, v1
    v_lshl_add_u32 v41, v42, 2, v41
    v_lshlrev_b32 v41, 7, v41
    v_lshl_add_u32 v38, v3, 2, v2
    s_lshl_b32 s84, s3, 7
    v_lshl_add_u32 v38, v38, 1, s84
    v_lshlrev_b32 v39, 4, v2
    v_mul_u32_u24 v44, 18432, v2
    v_lshl_add_u32 v44, v3, 2, v44
    s_mul_i32 s9, s12, 2304
    s_lshl_b32 s84, s13, 8
    s_add_u32 s9, s9, s84
    s_lshl_b32 s84, s3, 6
    s_add_u32 s9, s9, s84
    s_add_u32 s9, s9, 163840
    s_add_u32 s8, s9, 73728
    s_cmp_ge_u32 s3, 4
    s_cbranch_scc1 L_A_now
    v_lshl_add_u32 v47, v2, 3, v45
    v_lshlrev_b32 v47, 7, v47
    v_lshrrev_b32 v42, 1, v45
    v_and_b32 v43, 1, v2
    v_lshl_add_u32 v42, v43, 1, v42
    v_xor_b32 v42, s3, v42
    v_lshl_add_u32 v47, v42, 5, v47
    v_lshl_add_u32 v47, v46, 3, v47
    v_add_u32 v47, 20480, v47
    ds_read_b64_tr_b16 v[48:49], v47 offset:0
    ds_read_b64_tr_b16 v[50:51], v47 offset:512
    ds_read_b64_tr_b16 v[52:53], v47 offset:4096
    ds_read_b64_tr_b16 v[54:55], v47 offset:4608
    ds_read_b64_tr_b16 v[56:57], v47 offset:8192
    ds_read_b64_tr_b16 v[58:59], v47 offset:8704
    ds_read_b64_tr_b16 v[60:61], v47 offset:12288
    ds_read_b64_tr_b16 v[62:63], v47 offset:12800
    ds_read_b64_tr_b16 v[64:65], v47 offset:16384
    ds_read_b64_tr_b16 v[66:67], v47 offset:16896
    ds_read_b64_tr_b16 v[68:69], v47 offset:20480
    ds_read_b64_tr_b16 v[70:71], v47 offset:20992
    ds_read_b64_tr_b16 v[72:73], v47 offset:24576
    ds_read_b64_tr_b16 v[74:75], v47 offset:25088
    ds_read_b64_tr_b16 v[76:77], v47 offset:28672
    ds_read_b64_tr_b16 v[78:79], v47 offset:29184
    ds_read_b64_tr_b16 v[80:81], v47 offset:32768
    ds_read_b64_tr_b16 v[82:83], v47 offset:33280
    ds_read_b64_tr_b16 v[84:85], v47 offset:36864
    ds_read_b64_tr_b16 v[86:87], v47 offset:37376
    ds_read_b64_tr_b16 v[88:89], v47 offset:40960
    ds_read_b64_tr_b16 v[90:91], v47 offset:41472
    ds_read_b64_tr_b16 v[92:93], v47 offset:45056
    ds_read_b64_tr_b16 v[94:95], v47 offset:45568
    ds_read_b64_tr_b16 v[96:97], v47 offset:49152
    ds_read_b64_tr_b16 v[98:99], v47 offset:49664
    ds_read_b64_tr_b16 v[100:101], v47 offset:53248
    ds_read_b64_tr_b16 v[102:103], v47 offset:53760
    ds_read_b64_tr_b16 v[104:105], v47 offset:57344
    ds_read_b64_tr_b16 v[106:107], v47 offset:57856
    ds_read_b64_tr_b16 v[108:109], v47 offset:61440
    ds_read_b64_tr_b16 v[110:111], v47 offset:61952
L_A_now:
    buffer_load_dwordx4 v[184:187], v41, s[68:71], s15 offen sc1
    buffer_load_dwordx4 v[176:179], v40, s[68:71], s10 offen sc1
    buffer_load_dwordx4 v[180:183], v40, s[68:71], s10 offen offset:2048 sc1
L_A_poll:
    s_waitcnt vmcnt(0)
    v_msad_u8 v34, v176, v13, 0
    v_msad_u8 v35, v177, v13, 0
    v_msad_u8 v36, v178, v13, 0
    v_msad_u8 v34, v179, v13, v34
    v_msad_u8 v35, v180, v13, v35
    v_msad_u8 v36, v181, v13, v36
    v_msad_u8 v34, v182, v13, v34
    v_msad_u8 v35, v183, v13, v35
    v_msad_u8 v36, v184, v13, v36
    v_msad_u8 v34, v185, v13, v34
    v_msad_u8 v35, v186, v13, v35
    v_msad_u8 v36, v187, v13, v36
    v_or3_b32 v34, v34, v35, v36
    v_cmp_ne_u32 vcc, 0, v34
    s_cbranch_vccz L_A_got0
    buffer_load_dwordx4 v[184:187], v41, s[68:71], s15 offen sc1
    buffer_load_dwordx4 v[176:179], v40, s[68:71], s10 offen sc1
    buffer_load_dwordx4 v[180:183], v40, s[68:71], s10 offen offset:2048 sc1
    s_add_u32 s91, s91, 1
    s_cmp_gt_u32 s91, 2000000
    s_cbranch_scc1 L_END
    s_branch L_A_poll
L_A_got0:
    v_and_b32 v32, s35, v184
    s_nop 1
    v_max_f32_dpp v34, v32, v32 quad_perm:[1,0,3,2] row_mask:0xf bank_mask:0xf
    s_nop 1
    v_max_f32_dpp v34, v34, v34 quad_perm:[2,3,0,1] row_mask:0xf bank_mask:0xf
    s_nop 1
    v_max_f32_dpp v34, v34, v34 row_half_mirror row_mask:0xf bank_mask:0xf
    v_sub_f32 v35, v32, v34
    v_mul_f32 v35, s88, v35
    v_exp_f32 v35, v35
    s_nop 0
    v_mul_f32 v36, v35, v185
    v_mul_f32_dpp v24, v35, v176 row_newbcast:0 row_mask:0xf bank_mask:0xf
    v_mul_f32_dpp v25, v35, v177 row_newbcast:0 row_mask:0xf bank_mask:0xf
    v_mul_f32_dpp v26, v35, v178 row_newbcast:0 row_mask:0xf bank_mask:0xf
    v_mul_f32_dpp v27, v35, v179 row_newbcast:0 row_mask:0xf bank_mask:0xf
    v_add_f32_dpp v36, v36, v36 quad_perm:[1,0,3,2] row_mask:0xf bank_mask:0xf
    v_fmac_f32_dpp v24, v35, v180 row_newbcast:1 row_mask:0xf bank_mask:0xf
    v_fmac_f32_dpp v25, v35, v181 row_newbcast:1 row_mask:0xf bank_mask:0xf
    v_add_f32_dpp v36, v36, v36 quad_perm:[2,3,0,1] row_mask:0xf bank_mask:0xf
    v_fmac_f32_dpp v26, v35, v182 row_newbcast:1 row_mask:0xf bank_mask:0xf
    v_fmac_f32_dpp v27, v35, v183 row_newbcast:1 row_mask:0xf bank_mask:0xf
    v_add_f32_dpp v36, v36, v36 row_half_mirror row_mask:0xf bank_mask:0xf
    s_nop 0
L_A_go:
    v_permlane32_swap_b32 v24, v26
    v_permlane32_swap_b32 v25, v27
    v_rcp_f32 v36, v36
    v_pk_add_f32 v[24:25], v[24:25], v[26:27]
    s_nop 1
    v_permlane16_swap_b32 v24, v25
    v_add_f32 v24, v24, v25
    v_mul_f32 v36, v36, v24
    v_cvt_pk_bf16_f32 v36, v36, v36
    ds_write_b16 v38, v36 offset:4608
    s_waitcnt lgkmcnt(0)
    s_barrier
    s_cmp_ge_u32 s3, 4
    s_cbranch_scc1 L_FIN
    ds_read_b128 v[112:115], v39 offset:4608
    ds_read_b128 v[116:119], v39 offset:4672
    ds_read_b128 v[120:123], v39 offset:4736
    ds_read_b128 v[124:127], v39 offset:4800
    ds_read_b128 v[128:131], v39 offset:4864
    ds_read_b128 v[132:135], v39 offset:4928
    ds_read_b128 v[136:139], v39 offset:4992
    ds_read_b128 v[140:143], v39 offset:5056
    ds_read_b128 v[144:147], v39 offset:5120
    ds_read_b128 v[148:151], v39 offset:5184
    ds_read_b128 v[152:155], v39 offset:5248
    ds_read_b128 v[156:159], v39 offset:5312
    ds_read_b128 v[160:163], v39 offset:5376
    ds_read_b128 v[164:167], v39 offset:5440
    ds_read_b128 v[168:171], v39 offset:5504
    ds_read_b128 v[172:175], v39 offset:5568
    s_waitcnt lgkmcnt(15)
    v_mfma_f32_16x16x32_bf16 v[24:27], v[112:115], v[48:51], 0
    s_waitcnt lgkmcnt(14)
    v_mfma_f32_16x16x32_bf16 v[24:27], v[116:119], v[52:55], v[24:27]
    s_waitcnt lgkmcnt(13)
    v_mfma_f32_16x16x32_bf16 v[24:27], v[120:123], v[56:59], v[24:27]
    s_waitcnt lgkmcnt(12)
    v_mfma_f32_16x16x32_bf16 v[24:27], v[124:127], v[60:63], v[24:27]
    s_waitcnt lgkmcnt(11)
    v_mfma_f32_16x16x32_bf16 v[24:27], v[128:131], v[64:67], v[24:27]
    s_waitcnt lgkmcnt(10)
    v_mfma_f32_16x16x32_bf16 v[24:27], v[132:135], v[68:71], v[24:27]
    s_waitcnt lgkmcnt(9)
    v_mfma_f32_16x16x32_bf16 v[24:27], v[136:139], v[72:75], v[24:27]
    s_waitcnt lgkmcnt(8)
    v_mfma_f32_16x16x32_bf16 v[24:27], v[140:143], v[76:79], v[24:27]
    s_waitcnt lgkmcnt(7)
    v_mfma_f32_16x16x32_bf16 v[24:27], v[144:147], v[80:83], v[24:27]
    s_waitcnt lgkmcnt(6)
    v_mfma_f32_16x16x32_bf16 v[24:27], v[148:151], v[84:87], v[24:27]
    s_waitcnt lgkmcnt(5)
    v_mfma_f32_16x16x32_bf16 v[24:27], v[152:155], v[88:91], v[24:27]
    s_waitcnt lgkmcnt(4)
    v_mfma_f32_16x16x32_bf16 v[24:27], v[156:159], v[92:95], v[24:27]
    s_waitcnt lgkmcnt(3)
    v_mfma_f32_16x16x32_bf16 v[24:27], v[160:163], v[96:99], v[24:27]
    s_waitcnt lgkmcnt(2)
    v_mfma_f32_16x16x32_bf16 v[24:27], v[164:167], v[100:103], v[24:27]
    s_waitcnt lgkmcnt(1)
    v_mfma_f32_16x16x32_bf16 v[24:27], v[168:171], v[104:107], v[24:27]
    s_waitcnt lgkmcnt(0)
    v_mfma_f32_16x16x32_bf16 v[24:27], v[172:175], v[108:111], v[24:27]
    s_nop 7
    v_and_or_b32 v24, v24, s35, v13
    buffer_store_dword v24, v44, s[68:71], s9 offen sc1
    buffer_store_dword v24, v44, s[68:71], s8 offen sc1
    s_branch L_FIN
L_roleB:
    s_nop 3
    v_bfe_u32 v45, v1, 2, 2
    v_and_b32 v46, 3, v1
    s_getreg_b32 s4, hwreg(HW_REG_XCC_ID)
    s_mov_b32 s84, 0x3ffff
    s_mov_b32 s85, 0x3ffff
    s_mul_i32 s10, s3, 144
    v_and_b32 v41, 31, v1
    v_lshrrev_b32 v43, 5, v1
    v_lshl_add_u32 v114, v41, 1, v43
    v_lshl_add_u32 v40, v114, 2, s10
    v_mov_b32 v42, 1073741824
    v_cndmask_b32 v40, v42, v40, s[84:85]
    buffer_load_dword v44, v40, s[48:51], 0 offen
    v_mul_u32_u24 v43, 2304, v43
    v_lshl_add_u32 v41, v41, 4, v43
    s_lshl_b32 s10, s10, 1
    v_add_u32 v41, s10, v41
    v_cndmask_b32 v41, v42, v41, s[84:85]
    v_cndmask_b32 v116, 0, v13, s[84:85]
    s_and_b32 s4, s4, 7
    s_mul_i32 s4, s4, 18432
    s_add_u32 s4, s4, 163840
    s_add_u32 s5, s4, 4608
    s_add_u32 s6, s4, 9216
    s_add_u32 s7, s4, 13824
    s_and_b32 s10, s3, 3
    v_lshl_add_u32 v47, v2, 3, v45
    v_lshlrev_b32 v47, 7, v47
    v_lshrrev_b32 v42, 1, v45
    v_and_b32 v43, 1, v2
    v_lshl_add_u32 v42, v43, 1, v42
    v_xor_b32 v42, s10, v42
    v_lshl_add_u32 v47, v42, 5, v47
    v_lshl_add_u32 v47, v46, 3, v47
    v_add_u32 v47, 20480, v47
    s_lshr_b32 s10, s3, 2
    s_lshl_b32 s10, s10, 12
    v_add_u32 v47, s10, v47
    v_add_u32 v113, 36864, v47
    s_lshl_b32 s10, s3, 9
    s_add_u32 s10, s10, 6144
    v_and_b32 v92, 3, v114
    v_mul_u32_u24 v92, 96, v92
    v_lshrrev_b32 v42, 2, v114
    v_lshl_add_u32 v92, v42, 2, v92
    v_add_u32 v92, s10, v92
    v_lshrrev_b32 v42, 3, v1
    v_mul_u32_u24 v93, 48, v42
    v_add_u32 v93, s10, v93
    v_and_b32 v43, 7, v1
    v_bfe_u32 v42, v1, 3, 1
    v_lshrrev_b32 v95, 5, v1
    v_lshl_add_u32 v95, v42, 1, v95
    v_lshl_add_u32 v43, v95, 3, v43
    v_and_b32 v42, 1, v2
    v_lshl_add_u32 v43, v42, 5, v43
    v_lshl_add_u32 v95, v43, 1, s10
    v_lshl_add_u32 v96, v2, 4, s10
    s_lshl_b32 s10, s3, 3
    v_mov_b32 v117, s10
    v_mov_b32 v119, 0
    v_mul_u32_u24 v118, 36864, v2
    v_lshl_add_u32 v118, v3, 2, v118
    s_mul_i32 s10, s3, 4608
    s_lshl_b32 s15, s12, 6
    s_add_u32 s10, s10, s15
    s_add_u32 s10, s10, 1572864
    s_add_u32 s15, s10, 147456
    s_waitcnt vmcnt(0) lgkmcnt(0)
    s_barrier
    buffer_load_dwordx4 v[120:123], v41, s[68:71], s4 offen sc1
    buffer_load_dwordx4 v[124:127], v41, s[68:71], s5 offen sc1
    buffer_load_dwordx4 v[128:131], v41, s[68:71], s6 offen sc1
    buffer_load_dwordx4 v[132:135], v41, s[68:71], s7 offen sc1
    ds_read_b128 v[24:27], v97 offset:14848
    ds_read_b128 v[28:31], v97 offset:15392
    ds_read_b128 v[32:35], v97 offset:15936
    ds_read_b128 v[36:39], v97 offset:16480
    ds_read_b64_tr_b16 v[48:49], v47 offset:0
    ds_read_b64_tr_b16 v[50:51], v47 offset:512
    ds_read_b64_tr_b16 v[52:53], v113 offset:0
    ds_read_b64_tr_b16 v[54:55], v113 offset:512
    ds_read_b64_tr_b16 v[56:57], v47 offset:8192
    ds_read_b64_tr_b16 v[58:59], v47 offset:8704
    ds_read_b64_tr_b16 v[60:61], v113 offset:8192
    ds_read_b64_tr_b16 v[62:63], v113 offset:8704
    ds_read_b64_tr_b16 v[64:65], v47 offset:16384
    ds_read_b64_tr_b16 v[66:67], v47 offset:16896
    ds_read_b64_tr_b16 v[68:69], v113 offset:16384
    ds_read_b64_tr_b16 v[70:71], v113 offset:16896
    ds_read_b64_tr_b16 v[72:73], v47 offset:24576
    ds_read_b64_tr_b16 v[74:75], v47 offset:25088
    ds_read_b64_tr_b16 v[76:77], v113 offset:24576
    ds_read_b64_tr_b16 v[78:79], v113 offset:25088
    ds_read_b64_tr_b16 v[80:81], v47 offset:32768
    ds_read_b64_tr_b16 v[82:83], v47 offset:33280
    ds_read_b64_tr_b16 v[84:85], v113 offset:32768
    ds_read_b64_tr_b16 v[86:87], v113 offset:33280
    s_waitcnt lgkmcnt(15)
    v_pk_add_f32 v[24:25], v[24:25], v[28:29]
    v_pk_add_f32 v[26:27], v[26:27], v[30:31]
    v_pk_add_f32 v[32:33], v[32:33], v[36:37]
    v_pk_add_f32 v[34:35], v[34:35], v[38:39]
    v_pk_add_f32 v[24:25], v[24:25], v[32:33]
    v_pk_add_f32 v[26:27], v[26:27], v[34:35]
    s_nop 0
    v_add_f32_dpp v98, v24, v24 row_ror:8 row_mask:0xf bank_mask:0x3
    v_add_f32_dpp v99, v25, v25 row_ror:8 row_mask:0xf bank_mask:0x3
    s_nop 0
    v_add_f32_dpp v98, v26, v26 row_ror:8 row_mask:0xf bank_mask:0xc
    v_add_f32_dpp v99, v27, v27 row_ror:8 row_mask:0xf bank_mask:0xc
    s_nop 1
    v_permlane32_swap_b32 v98, v99
L_B_poll:
    s_waitcnt vmcnt(0)
    v_msad_u8 v40, v120, v116, 0
    v_msad_u8 v42, v121, v116, 0
    v_msad_u8 v43, v122, v116, 0
    v_msad_u8 v40, v123, v116, v40
    v_msad_u8 v42, v124, v116, v42
    v_msad_u8 v43, v125, v116, v43
    v_msad_u8 v40, v126, v116, v40
    v_msad_u8 v42, v127, v116, v42
    v_msad_u8 v43, v128, v116, v43
    v_msad_u8 v40, v129, v116, v40
    v_msad_u8 v42, v130, v116, v42
    v_msad_u8 v43, v131, v116, v43
    v_msad_u8 v40, v132, v116, v40
    v_msad_u8 v42, v133, v116, v42
    v_msad_u8 v43, v134, v116, v43
    v_msad_u8 v40, v135, v116, v40
    v_or3_b32 v40, v40, v42, v43
    v_cmp_ne_u32 vcc, 0, v40
    s_cbranch_vccz L_B_got0
    buffer_load_dwordx4 v[120:123], v41, s[68:71], s4 offen sc1
    buffer_load_dwordx4 v[124:127], v41, s[68:71], s5 offen sc1
    buffer_load_dwordx4 v[128:131], v41, s[68:71], s6 offen sc1
    buffer_load_dwordx4 v[132:135], v41, s[68:71], s7 offen sc1
    s_add_u32 s91, s91, 1
    s_cmp_gt_u32 s91, 2000000
    s_cbranch_scc1 L_END
    s_branch L_B_poll
L_B_got0:
    v_pk_add_f32 v[24:25], v[120:121], v[124:125]
    v_pk_add_f32 v[28:29], v[128:129], v[132:133]
    v_pk_add_f32 v[26:27], v[122:123], v[126:127]
    v_pk_add_f32 v[30:31], v[130:131], v[134:135]
L_B_go:
    v_pk_add_f32 v[24:25], v[24:25], v[28:29]
    v_pk_add_f32 v[28:29], v[26:27], v[30:31]
    v_lshlrev_b32 v26, 16, v44
    v_and_b32 v27, 0xffff0000, v44
    v_permlane32_swap_b32 v24, v28
    v_permlane32_swap_b32 v25, v29
    v_pk_add_f32 v[24:25], v[24:25], v[28:29]
    v_cvt_pk_bf16_f32 v28, v24, v25
    v_lshlrev_b32 v24, 16, v28
    v_and_b32 v25, 0xffff0000, v28
    v_pk_add_f32 v[24:25], v[24:25], v[26:27]
    v_cvt_pk_bf16_f32 v34, v24, v24
    v_cvt_pk_bf16_f32 v35, v25, v25
    s_mov_b64 exec, s[84:85]
    ds_write2_b32 v92, v34, v35 offset1:12
    s_mov_b64 exec, -1
    ds_read_b128 v[100:103], v93
    ds_read_b128 v[104:107], v93 offset:16
    ds_read_b32 v108, v93 offset:32
    v_and_b32 v34, 0xffff0000, v34
    v_and_b32 v35, 0xffff0000, v35
    v_add_f32 v110, v34, v35
    v_mul_f32 v111, v34, v34
    v_fmac_f32 v111, v35, v35
    v_add_f32_dpp v110, v110, v110 row_ror:8 row_mask:0xf bank_mask:0xf
    s_nop 0
    v_add_f32_dpp v111, v111, v111 row_ror:8 row_mask:0xf bank_mask:0xf
    v_add_f32_dpp v110, v110, v110 row_ror:4 row_mask:0xf bank_mask:0xf
    s_nop 0
    v_add_f32_dpp v111, v111, v111 row_ror:4 row_mask:0xf bank_mask:0xf
    v_add_f32_dpp v110, v110, v110 row_ror:2 row_mask:0xf bank_mask:0xf
    s_nop 0
    v_add_f32_dpp v111, v111, v111 row_ror:2 row_mask:0xf bank_mask:0xf
    v_add_f32_dpp v110, v110, v110 row_ror:1 row_mask:0xf bank_mask:0xf
    s_nop 0
    v_add_f32_dpp v111, v111, v111 row_ror:1 row_mask:0xf bank_mask:0xf
    v_add_f32_dpp v110, v110, v110 row_bcast:15 row_mask:0xa bank_mask:0xf
    s_nop 0
    v_add_f32_dpp v111, v111, v111 row_bcast:15 row_mask:0xa bank_mask:0xf
    v_add_f32_dpp v110, v110, v110 row_bcast:31 row_mask:0xc bank_mask:0xf
    s_nop 0
    v_add_f32_dpp v111, v111, v111 row_bcast:31 row_mask:0xc bank_mask:0xf
    s_waitcnt lgkmcnt(2)
    v_and_b32 v32, v100, v88
    v_and_b32 v33, v100, v89
    v_and_b32 v34, v100, v90
    v_and_b32 v35, v100, v91
    s_nop 1
    v_mfma_f32_16x16x32_bf16 v[24:27], v[176:179], v[32:35], 0
    v_mfma_f32_16x16x32_bf16 v[28:31], v[180:183], v[32:35], 0
    v_and_b32 v36, v101, v88
    v_and_b32 v37, v101, v89
    v_and_b32 v38, v101, v90
    v_and_b32 v39, v101, v91
    s_mov_b32 exec_lo, 0
    s_mov_b32 exec_hi, 0x80000000
    ds_write_b64 v117, v[110:111] offset:5888
    s_mov_b64 exec, -1
    v_mfma_f32_16x16x32_bf16 v[24:27], v[184:187], v[36:39], v[24:27]
    v_mfma_f32_16x16x32_bf16 v[28:31], v[188:191], v[36:39], v[28:31]
    v_and_b32 v32, v102, v88
    v_and_b32 v33, v102, v89
    v_and_b32 v34, v102, v90
    v_and_b32 v35, v102, v91
    s_nop 1
    v_mfma_f32_16x16x32_bf16 v[24:27], v[192:195], v[32:35], v[24:27]
    v_mfma_f32_16x16x32_bf16 v[28:31], v[196:199], v[32:35], v[28:31]
    v_and_b32 v36, v103, v88
    v_and_b32 v37, v103, v89
    v_and_b32 v38, v103, v90
    v_and_b32 v39, v103, v91
    s_nop 1
    v_mfma_f32_16x16x32_bf16 v[24:27], v[200:203], v[36:39], v[24:27]
    v_mfma_f32_16x16x32_bf16 v[28:31], v[204:207], v[36:39], v[28:31]
    s_waitcnt lgkmcnt(2)
    v_and_b32 v32, v104, v88
    v_and_b32 v33, v104, v89
    v_and_b32 v34, v104, v90
    v_and_b32 v35, v104, v91
    s_nop 1
    v_mfma_f32_16x16x32_bf16 v[24:27], v[208:211], v[32:35], v[24:27]
    v_mfma_f32_16x16x32_bf16 v[28:31], v[212:215], v[32:35], v[28:31]
    v_and_b32 v36, v105, v88
    v_and_b32 v37, v105, v89
    v_and_b32 v38, v105, v90
    v_and_b32 v39, v105, v91
    s_nop 1
    v_mfma_f32_16x16x32_bf16 v[24:27], v[216:219], v[36:39], v[24:27]
    v_mfma_f32_16x16x32_bf16 v[28:31], v[220:223], v[36:39], v[28:31]
    v_and_b32 v32, v106, v88
    v_and_b32 v33, v106, v89
    v_and_b32 v34, v106, v90
    v_and_b32 v35, v106, v91
    s_nop 1
    v_mfma_f32_16x16x32_bf16 v[24:27], v[224:227], v[32:35], v[24:27]
    v_mfma_f32_16x16x32_bf16 v[28:31], v[228:231], v[32:35], v[28:31]
    v_and_b32 v36, v107, v88
    v_and_b32 v37, v107, v89
    v_and_b32 v38, v107, v90
    v_and_b32 v39, v107, v91
    s_nop 1
    v_mfma_f32_16x16x32_bf16 v[24:27], v[232:235], v[36:39], v[24:27]
    v_mfma_f32_16x16x32_bf16 v[28:31], v[236:239], v[36:39], v[28:31]
    s_waitcnt lgkmcnt(1)
    v_and_b32 v32, v108, v88
    v_and_b32 v33, v108, v89
    v_and_b32 v34, v108, v90
    v_and_b32 v35, v108, v91
    s_nop 1
    v_mfma_f32_16x16x32_bf16 v[24:27], v[240:243], v[32:35], v[24:27]
    v_mfma_f32_16x16x32_bf16 v[28:31], v[244:247], v[32:35], v[28:31]
    s_nop 7
    v_permlane32_swap_b32 v24, v28
    v_permlane32_swap_b32 v25, v29
    v_permlane32_swap_b32 v26, v30
    v_permlane32_swap_b32 v27, v31
    v_add_f32_dpp v24, v28, v24 row_ror:8 row_mask:0xf bank_mask:0xf
    v_add_f32_dpp v25, v29, v25 row_ror:8 row_mask:0xf bank_mask:0xf
    v_add_f32_dpp v26, v30, v26 row_ror:8 row_mask:0xf bank_mask:0xf
    v_add_f32_dpp v27, v31, v27 row_ror:8 row_mask:0xf bank_mask:0xf
    s_mov_b32 exec_lo, 0x00ff00ff
    s_mov_b32 exec_hi, 0x00ff00ff
    ds_write_b128 v94, v[24:27] offset:10240
    s_mov_b64 exec, -1
    s_waitcnt lgkmcnt(0)
    s_barrier
    ds_read_b128 v[100:103], v119 offset:5888
    ds_read_b128 v[104:107], v119 offset:5904
    ds_read_b128 v[108:111], v119 offset:5920
    ds_read_b128 v[112:115], v119 offset:5936
    ds_read_b128 v[24:27], v97 offset:10240
    ds_read_b128 v[28:31], v97 offset:10784
    ds_read_b128 v[32:35], v97 offset:11328
    ds_read_b128 v[36:39], v97 offset:11872
    s_waitcnt lgkmcnt(4)
    v_pk_add_f32 v[100:101], v[100:101], v[102:103]
    v_pk_add_f32 v[104:105], v[104:105], v[106:107]
    v_pk_add_f32 v[108:109], v[108:109], v[110:111]
    v_pk_add_f32 v[112:113], v[112:113], v[114:115]
    v_pk_add_f32 v[100:101], v[100:101], v[104:105]
    v_pk_add_f32 v[108:109], v[108:109], v[112:113]
    v_pk_add_f32 v[100:101], v[100:101], v[108:109]
    v_mul_f32 v100, 0x3ae38e39, v100
    v_mul_f32 v101, 0x3ae38e39, v101
    v_fma_f32 v101, -v100, v100, v101
    v_max_f32 v101, 0, v101
    v_cvt_pk_bf16_f32 v105, v100, v101
    v_lshlrev_b32 v102, 16, v105
    v_and_b32 v105, 0xffff0000, v105
    v_add_f32 v105, 0x3727c5ac, v105
    v_cvt_pk_bf16_f32 v105, v105, v105
    v_lshlrev_b32 v105, 16, v105
    v_sqrt_f32 v105, v105
    s_nop 0
    v_cvt_pk_bf16_f32 v105, v105, v105
    v_lshlrev_b32 v103, 16, v105
    v_rcp_f32 v104, v103
    s_waitcnt lgkmcnt(2)
    v_pk_add_f32 v[24:25], v[24:25], v[28:29]
    v_pk_add_f32 v[26:27], v[26:27], v[30:31]
    s_waitcnt lgkmcnt(0)
    v_pk_add_f32 v[32:33], v[32:33], v[36:37]
    v_pk_add_f32 v[34:35], v[34:35], v[38:39]
    v_pk_add_f32 v[24:25], v[24:25], v[32:33]
    v_pk_add_f32 v[26:27], v[26:27], v[34:35]
    s_nop 0
    v_add_f32_dpp v28, v24, v24 row_ror:8 row_mask:0xf bank_mask:0x3
    v_add_f32_dpp v29, v25, v25 row_ror:8 row_mask:0xf bank_mask:0x3
    s_nop 0
    v_add_f32_dpp v28, v26, v26 row_ror:8 row_mask:0xf bank_mask:0xc
    v_add_f32_dpp v29, v27, v27 row_ror:8 row_mask:0xf bank_mask:0xc
    s_nop 1
    v_permlane32_swap_b32 v28, v29
    v_fma_f32 v28, -v102, v98, v28
    v_fma_f32 v29, -v102, v99, v29
    v_mul_f32 v28, v28, v104
    v_mul_f32 v29, v29, v104
    v_cvt_pk_bf16_f32 v30, v28, v29
    v_lshlrev_b32 v28, 16, v30
    v_and_b32 v29, 0xffff0000, v30
    v_mul_f32 v30, v28, v28
    v_mul_f32 v30, v30, v28
    v_mov_b32 v31, v28
    v_fmac_f32 v31, 0x3d372713, v30
    v_mul_f32 v31, 0xc0135761, v31
    v_exp_f32 v31, v31
    s_nop 0
    v_add_f32 v31, 1.0, v31
    v_rcp_f32 v31, v31
    s_nop 0
    v_mul_f32 v31, v28, v31
    v_cvt_pk_bf16_f32 v31, v31, v31
    v_lshlrev_b32 v31, 16, v31
    v_mul_f32 v31, v31, v29
    v_cvt_pk_bf16_f32 v31, v31, v31
    ds_write_b16 v95, v31 offset:384
    ds_read_b128 v[24:27], v96 offset:384
    ds_read_b128 v[28:31], v96 offset:448
    s_waitcnt lgkmcnt(1)
    v_mfma_f32_16x16x32_bf16 v[32:35], v[24:27], v[48:51], 0
    v_mfma_f32_16x16x32_bf16 v[36:39], v[24:27], v[56:59], 0
    v_mfma_f32_16x16x32_bf16 v[100:103], v[24:27], v[64:67], 0
    v_mfma_f32_16x16x32_bf16 v[104:107], v[24:27], v[72:75], 0
    v_mfma_f32_16x16x32_bf16 v[108:111], v[24:27], v[80:83], 0
    s_waitcnt lgkmcnt(0)
    v_mfma_f32_16x16x32_bf16 v[32:35], v[28:31], v[52:55], v[32:35]
    v_mfma_f32_16x16x32_bf16 v[36:39], v[28:31], v[60:63], v[36:39]
    v_mfma_f32_16x16x32_bf16 v[100:103], v[28:31], v[68:71], v[100:103]
    v_mfma_f32_16x16x32_bf16 v[104:107], v[28:31], v[76:79], v[104:107]
    v_mfma_f32_16x16x32_bf16 v[108:111], v[28:31], v[84:87], v[108:111]
    s_nop 4
    v_mov_b32_dpp v32, v36 quad_perm:[0,1,2,3] row_mask:0x2 bank_mask:0xf
    s_nop 1
    v_mov_b32_dpp v32, v100 quad_perm:[0,1,2,3] row_mask:0x4 bank_mask:0xf
    s_nop 1
    v_mov_b32_dpp v32, v104 quad_perm:[0,1,2,3] row_mask:0x8 bank_mask:0xf
    v_and_or_b32 v32, v32, s35, v13
    buffer_store_dword v32, v118, s[68:71], s10 offen sc1
    s_cmp_ge_u32 s3, 4
    s_cbranch_scc1 L_FIN
    s_mov_b64 exec, 0xffff
    v_and_or_b32 v108, v108, s35, v13
    buffer_store_dword v108, v118, s[68:71], s15 offen sc1
    s_branch L_FIN
L_roleC:
    s_nop 3
    s_cmp_ge_u32 s3, 1
    s_cbranch_scc1 L_FIN
    s_getreg_b32 s4, hwreg(HW_REG_XCC_ID)
    s_lshl_b32 s10, s12, 5
    v_lshl_add_u32 v44, v46, 2, v2
    v_lshl_add_u32 v44, v44, 1, s10
    buffer_load_ushort v43, v44, s[48:51], 0 offen
    v_lshrrev_b32 v41, 2, v1
    v_mul_u32_u24 v40, 2304, v41
    v_lshl_add_u32 v40, v46, 4, v40
    v_mov_b32 v42, 1073741824
    v_cmp_gt_u32 vcc, 32, v1
    s_nop 1
    v_cndmask_b32 v40, v42, v40, vcc
    v_cndmask_b32 v41, v42, v4, vcc
    v_cndmask_b32 v47, 0, v13, vcc
    s_and_b32 s4, s4, 7
    s_mul_i32 s4, s4, 18432
    s_lshl_b32 s5, s12, 6
    s_add_u32 s4, s4, s5
    s_add_u32 s4, s4, 163840
L_C_poll1:
    buffer_load_dwordx4 v[24:27], v40, s[68:71], s4 offen sc1
    s_waitcnt vmcnt(0)
    v_msad_u8 v36, v24, v47, 0
    v_msad_u8 v37, v25, v47, 0
    v_msad_u8 v36, v26, v47, v36
    v_msad_u8 v37, v27, v47, v37
    v_or_b32 v36, v36, v37
    v_cmp_ne_u32 vcc, 0, v36
    s_cbranch_vccz L_C_got1
    s_sleep 2
    s_add_u32 s91, s91, 1
    s_cmp_gt_u32 s91, 2000000
    s_cbranch_scc1 L_END
    s_branch L_C_poll1
L_C_got1:
    v_permlane32_swap_b32 v24, v26
    v_permlane32_swap_b32 v25, v27
    v_pk_add_f32 v[24:25], v[24:25], v[26:27]
    s_nop 1
    v_permlane16_swap_b32 v24, v25
    v_add_f32 v24, v24, v25
    s_nop 1
    v_add_f32_dpp v24, v24, v24 row_ror:8 row_mask:0xf bank_mask:0xf
    s_nop 1
    v_add_f32_dpp v24, v24, v24 row_ror:4 row_mask:0xf bank_mask:0xf
    v_cvt_pk_bf16_f32 v24, v24, v24
    v_lshlrev_b32 v24, 16, v24
    v_lshlrev_b32 v43, 16, v43
    v_add_f32 v43, v43, v24
    v_cvt_pk_bf16_f32 v43, v43, v43
    v_lshlrev_b32 v43, 16, v43
    s_mul_i32 s4, s12, 4608
    s_add_u32 s4, s4, 1572864
    s_add_u32 s5, s4, 4096
    buffer_load_dwordx4 v[48:51], v4, s[68:71], s4 offen offset:0 sc1
    buffer_load_dwordx4 v[52:55], v4, s[68:71], s4 offen offset:1024 sc1
    buffer_load_dwordx4 v[56:59], v4, s[68:71], s4 offen offset:2048 sc1
    buffer_load_dwordx4 v[60:63], v4, s[68:71], s4 offen offset:3072 sc1
    buffer_load_dwordx4 v[64:67], v41, s[68:71], s5 offen sc1
L_C2_poll:
    s_waitcnt vmcnt(0)
    v_msad_u8 v36, v48, v13, 0
    v_msad_u8 v37, v49, v13, 0
    v_msad_u8 v38, v50, v13, 0
    v_msad_u8 v36, v51, v13, v36
    v_msad_u8 v37, v52, v13, v37
    v_msad_u8 v38, v53, v13, v38
    v_msad_u8 v36, v54, v13, v36
    v_msad_u8 v37, v55, v13, v37
    v_msad_u8 v38, v56, v13, v38
    v_msad_u8 v36, v57, v13, v36
    v_msad_u8 v37, v58, v13, v37
    v_msad_u8 v38, v59, v13, v38
    v_msad_u8 v36, v60, v13, v36
    v_msad_u8 v37, v61, v13, v37
    v_msad_u8 v38, v62, v13, v38
    v_msad_u8 v36, v63, v13, v36
    v_msad_u8 v37, v64, v47, v37
    v_msad_u8 v38, v65, v47, v38
    v_msad_u8 v36, v66, v47, v36
    v_msad_u8 v37, v67, v47, v37
    v_or3_b32 v36, v36, v37, v38
    v_cmp_ne_u32 vcc, 0, v36
    s_cbranch_vccz L_C2_got0
    buffer_load_dwordx4 v[48:51], v4, s[68:71], s4 offen offset:0 sc1
    buffer_load_dwordx4 v[52:55], v4, s[68:71], s4 offen offset:1024 sc1
    buffer_load_dwordx4 v[56:59], v4, s[68:71], s4 offen offset:2048 sc1
    buffer_load_dwordx4 v[60:63], v4, s[68:71], s4 offen offset:3072 sc1
    buffer_load_dwordx4 v[64:67], v41, s[68:71], s5 offen sc1
    s_add_u32 s91, s91, 1
    s_cmp_gt_u32 s91, 2000000
    s_cbranch_scc1 L_END
    s_branch L_C2_poll
L_C2_got0:
    v_pk_add_f32 v[24:25], v[48:49], v[52:53]
    v_pk_add_f32 v[28:29], v[56:57], v[60:61]
    v_pk_add_f32 v[26:27], v[50:51], v[54:55]
    v_pk_add_f32 v[30:31], v[58:59], v[62:63]
    v_pk_add_f32 v[24:25], v[24:25], v[64:65]
    v_pk_add_f32 v[26:27], v[26:27], v[66:67]
L_C2_go:
    v_pk_add_f32 v[24:25], v[24:25], v[28:29]
    v_pk_add_f32 v[26:27], v[26:27], v[30:31]
    s_nop 1
    v_permlane32_swap_b32 v24, v26
    v_permlane32_swap_b32 v25, v27
    v_pk_add_f32 v[24:25], v[24:25], v[26:27]
    s_nop 1
    v_permlane16_swap_b32 v24, v25
    v_add_f32 v24, v24, v25
    s_nop 1
    v_add_f32_dpp v24, v24, v24 row_ror:8 row_mask:0xf bank_mask:0xf
    s_nop 1
    v_add_f32_dpp v24, v24, v24 row_ror:4 row_mask:0xf bank_mask:0xf
    v_cvt_pk_bf16_f32 v24, v24, v24
    v_lshlrev_b32 v24, 16, v24
    v_add_f32 v24, v24, v43
    v_cvt_pk_bf16_f32 v24, v24, v24
    s_mov_b32 exec_lo, 0x000f000f
    s_mov_b32 exec_hi, 0x000f000f
    buffer_store_short v24, v44, s[72:75], 0 offen
    s_cmp_eq_u32 s12, 0
    s_cbranch_scc0 L_FIN
    s_mov_b64 exec, 1
    s_mov_b32 s4, 786432
    buffer_store_dword v13, v4, s[68:71], s4 offen sc1
L_FIN:
    s_mov_b64 exec, -1
L_END:
    s_endpgm
.section .rodata,"a"
.p2align 6
.amdhsa_kernel sequential_preLN__mha_block_cached__glu_gated_geglu__decode_kernel
  .amdhsa_next_free_vgpr 256
  .amdhsa_next_free_sgpr 102
  .amdhsa_accum_offset 256
  .amdhsa_group_segment_fixed_size 0
  .amdhsa_kernarg_size 96
  .amdhsa_user_sgpr_count 2
  .amdhsa_user_sgpr_kernarg_segment_ptr 1
  .amdhsa_system_sgpr_workgroup_id_x 1
.end_amdhsa_kernel
```
